```python
import torch

def _softmax(x, axis=-1):
    return torch.softmax(x, dim=axis)

def _gelu(x):
    return torch.nn.functional.gelu(x, approximate='tanh')

def _silu(x):
    return torch.nn.functional.silu(x)

def _sigmoid(x):
    return torch.sigmoid(x)

def _layernorm(x, axis=-1, eps=1e-05):
    m = x.mean(dim=axis, keepdim=True)
    v = x.var(dim=axis, keepdim=True, unbiased=False)
    return (x - m) / torch.sqrt(v + eps)

def _scatter_add(tgt, idx, src, axis=0):
    return tgt.clone().index_add_(axis, idx, src)

def _segment_sum(src, seg, n):
    out = torch.zeros((n,) + src.shape[1:], dtype=src.dtype)
    return out.index_add_(0, seg, src)

def _pad(x, pw):
    flat = tuple((v for pair in reversed(pw) for v in pair))
    return torch.nn.functional.pad(x, flat)
kernel_name = 'gather_scatter__molecular_angular_painn__graph'

def setup_inputs():

    _w = lambda a: (lambda t: t.to(torch.bfloat16) if t.is_floating_point() else t)(torch.as_tensor(a))
    N, deg, D = (10000, 16, 128)
    n_rbf = max(16, 4)
    E = N * deg
    cutoff = 5.0
    freqs = (torch.arange(1, n_rbf + 1) * torch.pi / cutoff).to(float)
    return {'sv': _w((lambda *s: torch.randn(*s, dtype=torch.bfloat16) * 0.4)(N, 4, D) * 0.3), 'pos': _w((lambda *s: torch.randn(*s, dtype=torch.bfloat16) * 1.6)(N, 3) * 1.2), 'src': _w((lambda lo, hi, *s: torch.randint(lo, hi, s))(0, N, E).to(torch.int64)), 'dst': _w((lambda lo, hi, *s: torch.randint(lo, hi, s))(0, N, E).to(torch.int64)), 'freqs': _w(freqs), 'w_phi1': _w((lambda *s: torch.randn(*s, dtype=torch.bfloat16) * 3.2)(D, D) / D ** 0.5), 'w_phi2': _w((lambda *s: torch.randn(*s, dtype=torch.bfloat16) * 1.6)(D, 3 * D) / D ** 0.5), 'w_rbf': _w((lambda *s: torch.randn(*s, dtype=torch.bfloat16) * 1.6)(n_rbf, 3 * D) / n_rbf ** 0.5)}

def reference(sv, pos, src, dst, freqs, w_phi1, w_phi2, w_rbf):
    N, _, D = sv.shape
    E = src.shape[0]
    PI, cutoff = (3.141592653589793, 5.0)
    s, v = (sv[:, 0, :].clone(), sv[:, 1:, :].clone())
    r_vec = pos[src] - pos[dst]
    d = torch.sqrt((r_vec * r_vec).sum(-1) + 1e-08)
    r_hat = r_vec / d[:, None]
    rbf = torch.sin(d[:, None] * freqs[None, :]) / d[:, None]
    fcut = 0.5 * (torch.cos(PI * d / cutoff) + 1.0)
    fcut = torch.where(d < cutoff, fcut, 0.0 * d)
    Wf = rbf @ w_rbf * fcut[:, None]
    phi = (_silu(s @ w_phi1) @ w_phi2)[src]
    m = phi * Wf
    m_s, m_vv, m_vr = (m[:, :D].clone(), m[:, D:2 * D].clone(), m[:, 2 * D:].clone())
    ds = _segment_sum(m_s, dst, N)
    dv_e = m_vv[:, None, :] * v[src] + m_vr[:, None, :] * r_hat[:, :, None]
    dv = _segment_sum(dv_e.reshape(E, 3 * D), dst, N).reshape(N, 3, D)
    return sv + torch.concatenate([ds[:, None, :], dv], axis=1)
```

```asm
; @launch grid=(252,1,1) block=(1024,1,1) lds=163840
.amdgcn_target "amdgcn-amd-amdhsa--gfx950"
.text
.globl gather_scatter__molecular_angular_painn__graph_kernel
.p2align 8
.type gather_scatter__molecular_angular_painn__graph_kernel,@function
gather_scatter__molecular_angular_painn__graph_kernel:
    s_cmp_ge_u32 s2, 252
    s_cbranch_scc1 K_exit
    s_load_dwordx16 s[4:19], s[0:1], 0
    s_load_dwordx4 s[20:23], s[0:1], 64
    s_load_dwordx2 s[24:25], s[0:1], 80
    v_lshrrev_b32 v1, 6, v0
    s_nop 0
    v_readfirstlane_b32 s26, v1
    s_waitcnt lgkmcnt(0)
    s_mov_b32 s96, s22
    s_and_b32 s97, s23, 0xffff
    s_mov_b32 s98, 256
    s_mov_b32 s99, 0x00020000
    s_mov_b32 s101, 0
    s_cmp_ge_u32 s2, 236
    s_cbranch_scc1 ROLE_L
    s_cmp_ge_u32 s2, 79
    s_cbranch_scc1 ROLE_A
ROLE_B:
    s_mov_b32 s28, s8
    s_and_b32 s29, s9, 0xffff
    s_mov_b32 s30, 640000
    s_mov_b32 s31, 0x00020000
    s_mov_b32 s32, s10
    s_and_b32 s33, s11, 0xffff
    s_mov_b32 s34, 640000
    s_mov_b32 s35, 0x00020000
    s_mov_b32 s36, s6
    s_and_b32 s37, s7, 0xffff
    s_mov_b32 s38, 60000
    s_mov_b32 s39, 0x00020000
    s_sub_u32 s3, s2, 0
    s_lshl_b32 s3, s3, 11
    v_add_u32 v1, s3, v0
    v_add_u32 v2, 1024, v1
    v_lshlrev_b32 v3, 2, v1
    v_lshlrev_b32 v4, 2, v2
    buffer_load_dword v10, v3, s[28:31], 0 offen
    buffer_load_dword v11, v3, s[32:35], 0 offen
    buffer_load_dword v40, v4, s[28:31], 0 offen
    buffer_load_dword v41, v4, s[32:35], 0 offen
    s_barrier
    v_lshlrev_b32 v5, 4, v0
    v_add_u32 v6, 0x4000, v5
    v_add_u32 v7, 0x8000, v5
    v_add_u32 v8, 0xc000, v5
    buffer_load_dwordx4 v[72:75], v5, s[36:39], 0 offen
    buffer_load_dwordx4 v[76:79], v6, s[36:39], 0 offen
    buffer_load_dwordx4 v[80:83], v7, s[36:39], 0 offen
    buffer_load_dwordx4 v[84:87], v8, s[36:39], 0 offen
    s_add_u32 s40, s24, 14155776
    s_addc_u32 s41, s25, 0
    s_and_b32 s41, s41, 0xffff
    s_mov_b32 s42, 161538048
    s_mov_b32 s43, 0x00020000
    v_mov_b32 v9, 0
    v_lshlrev_b32 v70, 2, v0
    v_add_u32 v70, 65536, v70
    v_cmp_gt_u32 vcc, 64, v0
s_nop 0
    s_and_saveexec_b64 s[52:53], vcc
    ds_write_b32 v70, v9
    s_mov_b64 exec, s[52:53]
    v_mov_b32 v14, 0
    v_mov_b32 v15, 0
    v_mov_b32 v16, 0
    v_mov_b32 v17, 0
    v_mov_b32 v18, 0
    v_mov_b32 v19, 0
    v_mov_b32 v44, 0
    v_mov_b32 v45, 0
    v_mov_b32 v46, 0
    v_mov_b32 v47, 0
    v_mov_b32 v48, 0
    v_mov_b32 v49, 0
    s_mov_b32 s54, 0xffff0000
    s_mov_b32 s55, 0x322bcc77
    s_mov_b32 s56, 160000
    s_mov_b32 s57, 16541
    s_movk_i32 s58, 205
    s_movk_i32 s59, 160
    s_waitcnt vmcnt(0)
    ds_write_b128 v5, v[72:75]
    ds_write_b128 v6, v[76:79]
    ds_write_b128 v7, v[80:83]
    ds_write_b128 v8, v[84:87]
    s_waitcnt lgkmcnt(0)
    s_barrier
    v_mul_u32_u24 v12, 6, v10
    v_mul_u32_u24 v13, 6, v11
    ds_read_u16_d16_hi v14, v12 offset:0
    ds_read_u16_d16_hi v15, v12 offset:2
    ds_read_u16_d16_hi v16, v12 offset:4
    ds_read_u16_d16_hi v17, v13 offset:0
    ds_read_u16_d16_hi v18, v13 offset:2
    ds_read_u16_d16_hi v19, v13 offset:4
    v_mul_u32_u24 v42, 6, v40
    v_mul_u32_u24 v43, 6, v41
    ds_read_u16_d16_hi v44, v42 offset:0
    ds_read_u16_d16_hi v45, v42 offset:2
    ds_read_u16_d16_hi v46, v42 offset:4
    ds_read_u16_d16_hi v47, v43 offset:0
    ds_read_u16_d16_hi v48, v43 offset:2
    ds_read_u16_d16_hi v49, v43 offset:4
    v_mov_b32 v69, 1
    s_waitcnt lgkmcnt(6)
    v_sub_f32 v14, v14, v17
    v_sub_f32 v15, v15, v18
    v_sub_f32 v16, v16, v19
    v_cvt_pk_bf16_f32 v17, v14, v15
    v_cvt_pk_bf16_f32 v18, v16, v16
    v_lshlrev_b32 v14, 16, v17
    v_and_b32 v15, 0xffff0000, v17
    v_and_b32 v16, 0xffff0000, v18
    v_mul_f32 v17, v14, v14
    v_mul_f32 v18, v15, v15
    v_mul_f32 v19, v16, v16
    v_cvt_pk_bf16_f32 v17, v17, v18
    v_cvt_pk_bf16_f32 v19, v19, v19
    v_lshlrev_b32 v18, 16, v17
    v_and_b32 v17, 0xffff0000, v17
    v_and_b32 v19, 0xffff0000, v19
    v_add_f32 v17, v18, v17
    v_add_f32 v17, v17, v19
    v_cvt_pk_bf16_f32 v17, v17, v17
    v_and_b32 v17, 0xffff0000, v17
    v_add_f32 v17, 0x322bcc77, v17
    v_cvt_pk_bf16_f32 v17, v17, v17
    v_and_b32 v17, 0xffff0000, v17
    v_sqrt_f32 v17, v17
    v_lshrrev_b32 v24, 5, v11
    v_cvt_pk_bf16_f32 v17, v17, v17
    v_and_b32 v21, 0xffff, v17
    v_and_b32 v22, 0xffff0000, v17
    v_rcp_f32 v23, v22
    v_cmp_gt_u32 vcc, s57, v21
    v_cmp_gt_u32 s[60:61], s56, v1
    v_mul_u32_u24 v24, 205, v24
    s_and_b64 s[60:61], s[60:61], vcc
    v_mul_f32 v17, v14, v23
    v_mul_f32 v18, v15, v23
    v_mul_f32 v19, v16, v23
    v_cvt_pk_bf16_f32 v32, v17, v18
    v_cvt_pk_bf16_f32 v19, v19, v19
    v_lshrrev_b32 v24, 10, v24
    v_mul_u32_u24 v17, 160, v24
    v_sub_u32 v25, v11, v17
    v_mul_u32_u24 v26, 205, v25
    v_lshrrev_b32 v26, 11, v26
    v_mul_u32_u24 v17, 10, v26
    v_sub_u32 v27, v25, v17
    v_lshl_or_b32 v30, v10, 4, v26
    v_add_u32 v17, 16, v27
    v_lshlrev_b32 v17, v17, v69
    v_subrev_u32 v18, 14546, v21
    v_lshlrev_b32 v18, 5, v18
    v_and_b32 v18, 0xffff, v18
    v_or_b32 v31, v17, v18
    v_and_b32 v19, 0xffff, v19
    v_mul_u32_u24 v17, 3840, v26
    v_lshl_or_b32 v33, v17, 16, v19
    v_lshlrev_b32 v17, 2, v24
    v_add_u32 v17, 65536, v17
    s_mov_b64 exec, s[60:61]
    ds_add_rtn_u32 v28, v17, v69
    s_mov_b64 exec, -1
    s_waitcnt lgkmcnt(1)
    v_sub_f32 v44, v44, v47
    v_sub_f32 v45, v45, v48
    v_sub_f32 v46, v46, v49
    v_cvt_pk_bf16_f32 v47, v44, v45
    v_cvt_pk_bf16_f32 v48, v46, v46
    v_lshlrev_b32 v44, 16, v47
    v_and_b32 v45, 0xffff0000, v47
    v_and_b32 v46, 0xffff0000, v48
    v_mul_f32 v47, v44, v44
    v_mul_f32 v48, v45, v45
    v_mul_f32 v49, v46, v46
    v_cvt_pk_bf16_f32 v47, v47, v48
    v_cvt_pk_bf16_f32 v49, v49, v49
    v_lshlrev_b32 v48, 16, v47
    v_and_b32 v47, 0xffff0000, v47
    v_and_b32 v49, 0xffff0000, v49
    v_add_f32 v47, v48, v47
    v_add_f32 v47, v47, v49
    v_cvt_pk_bf16_f32 v47, v47, v47
    v_and_b32 v47, 0xffff0000, v47
    v_add_f32 v47, 0x322bcc77, v47
    v_cvt_pk_bf16_f32 v47, v47, v47
    v_and_b32 v47, 0xffff0000, v47
    v_sqrt_f32 v47, v47
    v_lshrrev_b32 v54, 5, v41
    v_cvt_pk_bf16_f32 v47, v47, v47
    v_and_b32 v51, 0xffff, v47
    v_and_b32 v52, 0xffff0000, v47
    v_rcp_f32 v53, v52
    v_cmp_gt_u32 vcc, s57, v51
    v_cmp_gt_u32 s[62:63], s56, v2
    v_mul_u32_u24 v54, 205, v54
    s_and_b64 s[62:63], s[62:63], vcc
    v_mul_f32 v47, v44, v53
    v_mul_f32 v48, v45, v53
    v_mul_f32 v49, v46, v53
    v_cvt_pk_bf16_f32 v62, v47, v48
    v_cvt_pk_bf16_f32 v49, v49, v49
    v_lshrrev_b32 v54, 10, v54
    v_mul_u32_u24 v47, 160, v54
    v_sub_u32 v55, v41, v47
    v_mul_u32_u24 v56, 205, v55
    v_lshrrev_b32 v56, 11, v56
    v_mul_u32_u24 v47, 10, v56
    v_sub_u32 v57, v55, v47
    v_lshl_or_b32 v60, v40, 4, v56
    v_add_u32 v47, 16, v57
    v_lshlrev_b32 v47, v47, v69
    v_subrev_u32 v48, 14546, v51
    v_lshlrev_b32 v48, 5, v48
    v_and_b32 v48, 0xffff, v48
    v_or_b32 v61, v47, v48
    v_and_b32 v49, 0xffff, v49
    v_mul_u32_u24 v47, 3840, v56
    v_lshl_or_b32 v63, v47, 16, v49
    v_lshlrev_b32 v47, 2, v54
    v_add_u32 v47, 65536, v47
    s_mov_b64 exec, s[62:63]
    ds_add_rtn_u32 v58, v47, v69
    s_mov_b64 exec, -1
    s_waitcnt lgkmcnt(0)
    s_barrier
    s_cmp_lg_u32 s26, 0
    s_cbranch_scc1 B_w0a
    ds_read_b32 v64, v70
    v_lshlrev_b32 v65, 2, v0
    s_waitcnt lgkmcnt(0)
    v_add_u32 v66, 3, v64
    v_and_b32 v66, -4, v66
    v_mov_b32 v67, v66
s_nop 1
    v_add_u32_dpp v67, v67, v67 row_shr:1 row_mask:0xf bank_mask:0xf bound_ctrl:0
s_nop 1
    v_add_u32_dpp v67, v67, v67 row_shr:2 row_mask:0xf bank_mask:0xf bound_ctrl:0
s_nop 1
    v_add_u32_dpp v67, v67, v67 row_shr:4 row_mask:0xf bank_mask:0xf bound_ctrl:0
s_nop 1
    v_add_u32_dpp v67, v67, v67 row_shr:8 row_mask:0xf bank_mask:0xf bound_ctrl:0
s_nop 1
    v_add_u32_dpp v67, v67, v67 row_bcast:15 row_mask:0xa bank_mask:0xf
s_nop 1
    v_add_u32_dpp v67, v67, v67 row_bcast:31 row_mask:0xc bank_mask:0xf
    v_mov_b32 v68, v66
    buffer_atomic_add v68, v65, s[96:99], 0 offen sc0
    v_readlane_b32 s48, v67, 63
    v_sub_u32 v67, v67, v66
    ds_write_b32 v70, v67 offset:256
    v_mov_b32 v71, s48
    v_mov_b32 v88, 66044
    ds_write_b32 v88, v71
    s_waitcnt lgkmcnt(0)
B_w0a:
    s_barrier
    v_lshlrev_b32 v14, 2, v24
    v_add_u32 v14, 65792, v14
    ds_read_b32 v15, v14
    v_lshlrev_b32 v44, 2, v54
    v_add_u32 v44, 65792, v44
    ds_read_b32 v45, v44
    v_mov_b32 v88, 66044
    ds_read_b32 v89, v88
    s_waitcnt lgkmcnt(2)
    v_add_u32 v15, v15, v28
    v_lshlrev_b32 v15, 4, v15
    v_add_u32 v15, 68608, v15
    s_mov_b64 exec, s[60:61]
    ds_write_b128 v15, v[30:33]
    s_mov_b64 exec, -1
    s_waitcnt lgkmcnt(1)
    v_add_u32 v45, v45, v58
    v_lshlrev_b32 v45, 4, v45
    v_add_u32 v45, 68608, v45
    s_mov_b64 exec, s[62:63]
    ds_write_b128 v45, v[60:63]
    s_mov_b64 exec, -1
    s_waitcnt lgkmcnt(0)
    v_readfirstlane_b32 s48, v89
    s_cmp_lg_u32 s26, 0
    s_cbranch_scc1 B_w0b
    v_add_u32 v71, v67, v64
    v_add_u32 v88, v67, v66
    v_mov_b32 v89, -1
    v_cmp_gt_u32 vcc, v88, v71
    v_lshlrev_b32 v90, 4, v71
    v_add_u32 v90, 68608, v90
    s_and_saveexec_b64 s[52:53], vcc
    ds_write_b32 v90, v89
    s_mov_b64 exec, s[52:53]
    v_add_u32 v71, 1, v71
    v_cmp_gt_u32 vcc, v88, v71
    v_lshlrev_b32 v90, 4, v71
    v_add_u32 v90, 68608, v90
    s_and_saveexec_b64 s[52:53], vcc
    ds_write_b32 v90, v89
    s_mov_b64 exec, s[52:53]
    v_add_u32 v71, 1, v71
    v_cmp_gt_u32 vcc, v88, v71
    v_lshlrev_b32 v90, 4, v71
    v_add_u32 v90, 68608, v90
    s_and_saveexec_b64 s[52:53], vcc
    ds_write_b32 v90, v89
    s_mov_b64 exec, s[52:53]
    s_mov_b32 s3, 2564096
    v_mul_lo_u32 v90, s3, v0
    s_waitcnt vmcnt(0)
    v_readlane_b32 s101, v68, 63
    v_sub_u32 v68, v68, v67
    v_lshl_add_u32 v90, v68, 4, v90
    v_add_u32 v71, 66048, v67
    v_add_u32 v88, 66048, v88
B_gt:
    v_cmp_gt_u32 vcc, v88, v71
s_nop 0
    s_and_saveexec_b64 s[52:53], vcc
    s_cbranch_execz B_gt_done
    ds_write_b32 v71, v90
    v_add_u32 v71, 4, v71
    s_mov_b64 exec, s[52:53]
    s_branch B_gt
B_gt_done:
    s_mov_b64 exec, s[52:53]
    s_waitcnt lgkmcnt(0)
B_w0b:
    s_barrier
    v_add_u32 v3, 0, v0
    v_cmp_gt_u32 vcc, s48, v3
    v_lshlrev_b32 v4, 4, v3
    v_and_b32 v5, -4, v3
    v_add_u32 v6, 68608, v4
    v_add_u32 v5, 66048, v5
    s_and_saveexec_b64 s[52:53], vcc
    ds_read_b128 v[72:75], v6
    ds_read_b32 v84, v5
    s_waitcnt lgkmcnt(0)
    v_add_u32 v4, v4, v84
    buffer_store_dwordx4 v[72:75], v4, s[40:43], 0 offen sc1
    s_mov_b64 exec, s[52:53]
    v_add_u32 v3, 1024, v0
    v_cmp_gt_u32 vcc, s48, v3
    v_lshlrev_b32 v4, 4, v3
    v_and_b32 v5, -4, v3
    v_add_u32 v6, 68608, v4
    v_add_u32 v5, 66048, v5
    s_and_saveexec_b64 s[52:53], vcc
    ds_read_b128 v[76:79], v6
    ds_read_b32 v85, v5
    s_waitcnt lgkmcnt(0)
    v_add_u32 v4, v4, v85
    buffer_store_dwordx4 v[76:79], v4, s[40:43], 0 offen sc1
    s_mov_b64 exec, s[52:53]
    s_cmp_le_u32 s48, 2048
    s_cbranch_scc1 B_done
    v_add_u32 v3, 2048, v0
    v_cmp_gt_u32 vcc, s48, v3
    v_lshlrev_b32 v4, 4, v3
    v_and_b32 v5, -4, v3
    v_add_u32 v6, 68608, v4
    v_add_u32 v5, 66048, v5
    s_and_saveexec_b64 s[52:53], vcc
    ds_read_b128 v[80:83], v6
    ds_read_b32 v86, v5
    s_waitcnt lgkmcnt(0)
    v_add_u32 v4, v4, v86
    buffer_store_dwordx4 v[80:83], v4, s[40:43], 0 offen sc1
    s_mov_b64 exec, s[52:53]
B_done:
    s_mov_b32 s100, 1
    s_branch PH2
ROLE_L:
    s_cmp_lg_u32 s2, 236
    s_cbranch_scc1 L_nozero
    s_cmp_lg_u32 s26, 0
    s_cbranch_scc1 L_nozero
    s_add_u32 s28, s24, 13160448
    s_addc_u32 s29, s25, 0
    s_and_b32 s29, s29, 0xffff
    s_mov_b32 s30, 4096
    s_mov_b32 s31, 0x00020000
    v_lshlrev_b32 v1, 7, v0
    v_mov_b32 v2, 0
    buffer_store_dword v2, v1, s[28:31], 0 offen sc1
    s_waitcnt vmcnt(0)
    v_mov_b32 v1, 252
    v_mov_b32 v2, 1
    s_mov_b64 exec, 1
    buffer_atomic_add v2, v1, s[96:99], 0 offen
    s_mov_b64 exec, -1
L_nozero:
    s_mov_b32 s28, s12
    s_and_b32 s29, s13, 0xffff
    s_mov_b32 s30, 32
    s_mov_b32 s31, 0x00020000
    s_add_u32 s32, s24, 12800000
    s_addc_u32 s33, s25, 0
    s_and_b32 s33, s33, 0xffff
    s_mov_b32 s34, 65536
    s_mov_b32 s35, 0x00020000
    s_sub_u32 s3, s2, 236
    s_lshl_b32 s3, s3, 10
    v_add_u32 v1, s3, v0
    v_and_b32 v2, 7, v1
    v_lshrrev_b32 v3, 3, v1
    v_lshlrev_b32 v4, 2, v2
    buffer_load_dword v5, v4, s[28:31], 0 offen
    v_add_u32 v6, 14546, v3
    v_lshlrev_b32 v6, 16, v6
    v_rcp_f32 v7, v6
    s_mov_b32 s54, 0xffff0000
    s_mov_b32 s55, 0x40490fdb
    s_mov_b32 s56, 0x3e4ccccd
    s_mov_b32 s57, 0x3e22f983
    v_mul_f32 v8, s55, v6
    v_cvt_pk_bf16_f32 v8, v8, v8
    v_lshlrev_b32 v8, 16, v8
    v_mul_f32 v8, s56, v8
    v_cvt_pk_bf16_f32 v8, v8, v8
    v_lshlrev_b32 v8, 16, v8
    v_mul_f32 v8, s57, v8
    v_fract_f32 v8, v8
    v_cos_f32 v8, v8
s_nop 0
    v_cvt_pk_bf16_f32 v8, v8, v8
    v_lshlrev_b32 v8, 16, v8
    v_add_f32 v8, 1.0, v8
    v_cvt_pk_bf16_f32 v8, v8, v8
    v_lshlrev_b32 v8, 16, v8
    v_mul_f32 v8, 0.5, v8
    v_cvt_pk_bf16_f32 v8, v8, v8
    v_lshlrev_b32 v8, 16, v8
    s_waitcnt vmcnt(0)
    v_lshlrev_b32 v9, 16, v5
    v_and_b32 v10, s54, v5
    v_mul_f32 v9, v6, v9
    v_cvt_pk_bf16_f32 v9, v9, v9
    v_lshlrev_b32 v9, 16, v9
    v_mul_f32 v9, s57, v9
    v_fract_f32 v9, v9
    v_sin_f32 v9, v9
s_nop 0
    v_cvt_pk_bf16_f32 v9, v9, v9
    v_lshlrev_b32 v9, 16, v9
    v_mul_f32 v9, v9, v7
    v_cvt_pk_bf16_f32 v9, v9, v9
    v_lshlrev_b32 v9, 16, v9
    v_mul_f32 v9, v9, v8
    v_mul_f32 v10, v6, v10
    v_cvt_pk_bf16_f32 v10, v10, v10
    v_lshlrev_b32 v10, 16, v10
    v_mul_f32 v10, s57, v10
    v_fract_f32 v10, v10
    v_sin_f32 v10, v10
s_nop 0
    v_cvt_pk_bf16_f32 v10, v10, v10
    v_lshlrev_b32 v10, 16, v10
    v_mul_f32 v10, v10, v7
    v_cvt_pk_bf16_f32 v10, v10, v10
    v_lshlrev_b32 v10, 16, v10
    v_mul_f32 v10, v10, v8
    v_cvt_pk_bf16_f32 v9, v9, v10
    v_lshlrev_b32 v11, 2, v1
    buffer_store_dword v9, v11, s[32:35], 0 offen sc1
    s_mov_b32 s100, 1
    s_branch PH2
ROLE_A:
    v_and_b32 v2, 63, v0
    v_and_b32 v3, 15, v2
    v_lshrrev_b32 v4, 4, v2
    s_sub_u32 s27, s2, 79
    s_lshl_b32 s27, s27, 6
    s_mov_b32 s28, s4
    s_and_b32 s29, s5, 0xffff
    s_mov_b32 s30, 10240000
    s_mov_b32 s31, 0x00020000
    s_cmp_ge_u32 s26, 4
    s_cbranch_scc1 A_nos
    s_lshl_b32 s55, s26, 4
    s_add_u32 s55, s55, s27
    v_add_u32 v7, 0, v4
    v_xor_b32 v8, v7, v3
    v_add_u32 v9, s55, v7
    v_lshlrev_b32 v9, 10, v9
    v_lshl_add_u32 v9, v8, 4, v9
    buffer_load_dwordx4 v[64:67], v9, s[28:31], 0 offen
    v_add_u32 v7, 4, v4
    v_xor_b32 v8, v7, v3
    v_add_u32 v9, s55, v7
    v_lshlrev_b32 v9, 10, v9
    v_lshl_add_u32 v9, v8, 4, v9
    buffer_load_dwordx4 v[68:71], v9, s[28:31], 0 offen
    v_add_u32 v7, 8, v4
    v_xor_b32 v8, v7, v3
    v_add_u32 v9, s55, v7
    v_lshlrev_b32 v9, 10, v9
    v_lshl_add_u32 v9, v8, 4, v9
    buffer_load_dwordx4 v[72:75], v9, s[28:31], 0 offen
    v_add_u32 v7, 12, v4
    v_xor_b32 v8, v7, v3
    v_add_u32 v9, s55, v7
    v_lshlrev_b32 v9, 10, v9
    v_lshl_add_u32 v9, v8, 4, v9
    buffer_load_dwordx4 v[76:79], v9, s[28:31], 0 offen
A_nos:
    s_mov_b32 s57, s26
    v_mov_b32 v15, v0
    s_cmp_ge_u32 s57, 12
    s_cbranch_scc1 A_w1
    s_mov_b32 s32, s16
    s_and_b32 s33, s17, 0xffff
    s_mov_b32 s34, 98304
    s_mov_b32 s35, 0x00020000
    s_movk_i32 s56, 768
    s_mov_b32 s57, 0
    v_mul_u32_u24 v10, 1366, v15
    v_lshrrev_b32 v10, 16, v10
    v_mul_u32_u24 v11, 48, v10
    v_sub_u32 v11, v15, v11
    s_branch A_wj
A_w1:
    s_mov_b32 s32, s14
    s_and_b32 s33, s15, 0xffff
    s_mov_b32 s34, 32768
    s_mov_b32 s35, 0x00020000
    s_movk_i32 s56, 256
    s_mov_b32 s57, 98304
    v_subrev_u32 v11, 768, v15
    v_lshrrev_b32 v10, 4, v11
    v_and_b32 v11, 15, v11
A_wj:
    s_lshl_b32 s58, s56, 3
    v_mul_u32_u24 v12, s58, v10
    v_lshl_add_u32 v12, v11, 4, v12
    buffer_load_dwordx4 v[16:19], v12, s[32:35], 0 offen
    v_add_u32 v12, s56, v12
    buffer_load_dwordx4 v[20:23], v12, s[32:35], 0 offen
    v_add_u32 v12, s56, v12
    buffer_load_dwordx4 v[24:27], v12, s[32:35], 0 offen
    v_add_u32 v12, s56, v12
    buffer_load_dwordx4 v[28:31], v12, s[32:35], 0 offen
    v_add_u32 v12, s56, v12
    buffer_load_dwordx4 v[32:35], v12, s[32:35], 0 offen
    v_add_u32 v12, s56, v12
    buffer_load_dwordx4 v[36:39], v12, s[32:35], 0 offen
    v_add_u32 v12, s56, v12
    buffer_load_dwordx4 v[40:43], v12, s[32:35], 0 offen
    v_add_u32 v12, s56, v12
    buffer_load_dwordx4 v[44:47], v12, s[32:35], 0 offen
    s_and_b32 s52, s26, 3
    s_lshr_b32 s53, s26, 2
    s_lshl_b32 s54, s53, 4
    s_add_u32 s54, s54, s27
    v_lshrrev_b32 v12, 2, v11
    v_lshlrev_b32 v13, 13, v12
    v_lshl_add_u32 v13, v10, 8, v13
    v_and_b32 v14, 3, v11
    v_lshl_add_u32 v13, v14, 6, v13
    v_add_u32 v13, s57, v13
    v_and_b32 v14, 2, v14
    v_and_b32 v12, 1, v12
    v_xor_b32 v14, v14, v12
    v_lshlrev_b32 v14, 4, v14
    v_xor_b32 v12, 0, v14
    v_add_u32 v120, v13, v12
    v_xor_b32 v12, 16, v14
    v_add_u32 v121, v13, v12
    v_xor_b32 v12, 32, v14
    v_add_u32 v122, v13, v12
    v_xor_b32 v12, 48, v14
    v_add_u32 v123, v13, v12
    s_mov_b32 s58, 0x05040100
    s_mov_b32 s59, 0x07060302
    s_lshl_b32 s55, s26, 12
    s_add_u32 s55, s55, 131072
    v_lshl_add_u32 v15, v2, 4, s55
    s_waitcnt vmcnt(0)
    v_perm_b32 v48, v20, v16, s58
    v_perm_b32 v49, v28, v24, s58
    v_perm_b32 v50, v36, v32, s58
    v_perm_b32 v51, v44, v40, s58
    ds_write_b128 v120, v[48:51] offset:0
    v_perm_b32 v52, v20, v16, s59
    v_perm_b32 v53, v28, v24, s59
    v_perm_b32 v54, v36, v32, s59
    v_perm_b32 v55, v44, v40, s59
    ds_write_b128 v120, v[52:55] offset:4096
    v_perm_b32 v56, v21, v17, s58
    v_perm_b32 v57, v29, v25, s58
    v_perm_b32 v58, v37, v33, s58
    v_perm_b32 v59, v45, v41, s58
    ds_write_b128 v121, v[56:59] offset:0
    v_perm_b32 v60, v21, v17, s59
    v_perm_b32 v61, v29, v25, s59
    v_perm_b32 v62, v37, v33, s59
    v_perm_b32 v63, v45, v41, s59
    ds_write_b128 v121, v[60:63] offset:4096
    v_perm_b32 v48, v22, v18, s58
    v_perm_b32 v49, v30, v26, s58
    v_perm_b32 v50, v38, v34, s58
    v_perm_b32 v51, v46, v42, s58
    ds_write_b128 v122, v[48:51] offset:0
    v_perm_b32 v52, v22, v18, s59
    v_perm_b32 v53, v30, v26, s59
    v_perm_b32 v54, v38, v34, s59
    v_perm_b32 v55, v46, v42, s59
    ds_write_b128 v122, v[52:55] offset:4096
    v_perm_b32 v56, v23, v19, s58
    v_perm_b32 v57, v31, v27, s58
    v_perm_b32 v58, v39, v35, s58
    v_perm_b32 v59, v47, v43, s58
    ds_write_b128 v123, v[56:59] offset:0
    v_perm_b32 v60, v23, v19, s59
    v_perm_b32 v61, v31, v27, s59
    v_perm_b32 v62, v39, v35, s59
    v_perm_b32 v63, v47, v43, s59
    ds_write_b128 v123, v[60:63] offset:4096
    s_cmp_ge_u32 s26, 4
    s_cbranch_scc1 A_nos2
    ds_write_b128 v15, v[64:67] offset:0
    ds_write_b128 v15, v[68:71] offset:1024
    ds_write_b128 v15, v[72:75] offset:2048
    ds_write_b128 v15, v[76:79] offset:3072
A_nos2:
    s_cmp_lg_u32 s26, 0
    s_cbranch_scc1 A_nozf
    v_mov_b32 v5, 252
    buffer_load_dword v116, v5, s[96:99], 0 offen sc1
A_nozf:
    s_waitcnt lgkmcnt(0)
    s_barrier
    s_mul_i32 s55, s26, 192
    s_mov_b32 s56, 43691
    v_add_u32 v5, s55, v2
    v_mul_u32_u24 v6, s56, v5
    v_lshrrev_b32 v6, 21, v6
    v_mul_u32_u24 v7, 48, v6
    v_sub_u32 v7, v5, v7
    v_add_u32 v8, s27, v6
    v_lshlrev_b32 v8, 10, v8
    v_lshl_add_u32 v8, v7, 4, v8
    buffer_load_dwordx4 v[104:107], v8, s[28:31], 0 offen offset:256
    v_lshrrev_b32 v8, 2, v7
    v_and_b32 v9, 1, v6
    v_xor_b32 v8, v8, v9
    v_lshlrev_b32 v8, 6, v8
    v_and_b32 v7, 3, v7
    v_lshl_add_u32 v8, v7, 4, v8
    v_mul_u32_u24 v6, 768, v6
    v_add_u32 v8, v8, v6
    v_add_u32 v117, 98304, v8
    v_add_u32 v5, s55, v2
    v_add_u32 v5, 64, v5
    v_mul_u32_u24 v6, s56, v5
    v_lshrrev_b32 v6, 21, v6
    v_mul_u32_u24 v7, 48, v6
    v_sub_u32 v7, v5, v7
    v_add_u32 v8, s27, v6
    v_lshlrev_b32 v8, 10, v8
    v_lshl_add_u32 v8, v7, 4, v8
    buffer_load_dwordx4 v[108:111], v8, s[28:31], 0 offen offset:256
    v_lshrrev_b32 v8, 2, v7
    v_and_b32 v9, 1, v6
    v_xor_b32 v8, v8, v9
    v_lshlrev_b32 v8, 6, v8
    v_and_b32 v7, 3, v7
    v_lshl_add_u32 v8, v7, 4, v8
    v_mul_u32_u24 v6, 768, v6
    v_add_u32 v8, v8, v6
    v_add_u32 v118, 98304, v8
    v_add_u32 v5, s55, v2
    v_add_u32 v5, 128, v5
    v_mul_u32_u24 v6, s56, v5
    v_lshrrev_b32 v6, 21, v6
    v_mul_u32_u24 v7, 48, v6
    v_sub_u32 v7, v5, v7
    v_add_u32 v8, s27, v6
    v_lshlrev_b32 v8, 10, v8
    v_lshl_add_u32 v8, v7, 4, v8
    buffer_load_dwordx4 v[112:115], v8, s[28:31], 0 offen offset:256
    v_lshrrev_b32 v8, 2, v7
    v_and_b32 v9, 1, v6
    v_xor_b32 v8, v8, v9
    v_lshlrev_b32 v8, 6, v8
    v_and_b32 v7, 3, v7
    v_lshl_add_u32 v8, v7, 4, v8
    v_mul_u32_u24 v6, 768, v6
    v_add_u32 v8, v8, v6
    v_add_u32 v119, 98304, v8
    s_lshl_b32 s55, s52, 13
    s_add_u32 s56, s55, 98304
    v_lshrrev_b32 v9, 3, v3
    v_lshlrev_b32 v9, 1, v9
    v_xor_b32 v9, v9, v3
    s_and_b32 s58, s52, 1
    v_xor_b32 v9, s58, v9
    v_lshlrev_b32 v9, 4, v9
    v_lshl_add_u32 v9, v4, 8, v9
    v_add_u32 v10, s56, v9
    s_lshl_b32 s57, s53, 12
    s_add_u32 s57, s57, 131072
    v_xor_b32 v11, v4, v3
    v_lshlrev_b32 v11, 4, v11
    v_lshl_add_u32 v12, v3, 8, s57
    v_xor_b32 v13, 0, v11
    v_add_u32 v13, v13, v12
    ds_read_b128 v[16:19], v13
    v_xor_b32 v13, 64, v11
    v_add_u32 v13, v13, v12
    ds_read_b128 v[20:23], v13
    v_xor_b32 v13, 128, v11
    v_add_u32 v13, v13, v12
    ds_read_b128 v[24:27], v13
    v_xor_b32 v13, 192, v11
    v_add_u32 v13, v13, v12
    ds_read_b128 v[28:31], v13
    ds_read_b128 v[32:35], v10 offset:0
    ds_read_b128 v[36:39], v10 offset:1024
    ds_read_b128 v[40:43], v10 offset:2048
    ds_read_b128 v[44:47], v10 offset:3072
    ds_read_b128 v[48:51], v10 offset:4096
    ds_read_b128 v[52:55], v10 offset:5120
    ds_read_b128 v[56:59], v10 offset:6144
    ds_read_b128 v[60:63], v10 offset:7168
    s_waitcnt lgkmcnt(7)
    v_mfma_f32_16x16x32_bf16 v[80:83], v[32:35], v[16:19], 0
    s_waitcnt lgkmcnt(6)
    v_mfma_f32_16x16x32_bf16 v[80:83], v[36:39], v[20:23], v[80:83]
    s_waitcnt lgkmcnt(5)
    v_mfma_f32_16x16x32_bf16 v[80:83], v[40:43], v[24:27], v[80:83]
    s_waitcnt lgkmcnt(4)
    v_mfma_f32_16x16x32_bf16 v[80:83], v[44:47], v[28:31], v[80:83]
    s_waitcnt lgkmcnt(3)
    v_mfma_f32_16x16x32_bf16 v[84:87], v[48:51], v[16:19], 0
    s_waitcnt lgkmcnt(2)
    v_mfma_f32_16x16x32_bf16 v[84:87], v[52:55], v[20:23], v[84:87]
    s_waitcnt lgkmcnt(1)
    v_mfma_f32_16x16x32_bf16 v[84:87], v[56:59], v[24:27], v[84:87]
    s_waitcnt lgkmcnt(0)
    v_mfma_f32_16x16x32_bf16 v[84:87], v[60:63], v[28:31], v[84:87]
    v_add_u32 v10, s55, v9
    v_add_u32 v14, 0x10000, v10
    ds_read_b128 v[32:35], v10 offset:0
    ds_read_b128 v[36:39], v10 offset:1024
    ds_read_b128 v[40:43], v10 offset:2048
    ds_read_b128 v[44:47], v10 offset:3072
    ds_read_b128 v[48:51], v10 offset:4096
    ds_read_b128 v[52:55], v10 offset:5120
    ds_read_b128 v[56:59], v10 offset:6144
    ds_read_b128 v[60:63], v10 offset:7168
    s_mov_b32 s58, 0xbfb8aa3b
    v_mul_f32 v16, s58, v80
    v_mul_f32 v17, s58, v81
    v_mul_f32 v18, s58, v82
    v_mul_f32 v19, s58, v83
    v_mul_f32 v20, s58, v84
    v_mul_f32 v21, s58, v85
    v_mul_f32 v22, s58, v86
    v_mul_f32 v23, s58, v87
    v_exp_f32 v16, v16
    v_exp_f32 v17, v17
    v_exp_f32 v18, v18
    v_exp_f32 v19, v19
    v_exp_f32 v20, v20
    v_exp_f32 v21, v21
    v_exp_f32 v22, v22
    v_exp_f32 v23, v23
    v_add_f32 v16, 1.0, v16
    v_add_f32 v17, 1.0, v17
    v_add_f32 v18, 1.0, v18
    v_add_f32 v19, 1.0, v19
    v_add_f32 v20, 1.0, v20
    v_add_f32 v21, 1.0, v21
    v_add_f32 v22, 1.0, v22
    v_add_f32 v23, 1.0, v23
    v_rcp_f32 v16, v16
    v_rcp_f32 v17, v17
    v_rcp_f32 v18, v18
    v_rcp_f32 v19, v19
    v_rcp_f32 v20, v20
    v_rcp_f32 v21, v21
    v_rcp_f32 v22, v22
    v_rcp_f32 v23, v23
    v_mul_f32 v16, v80, v16
    v_mul_f32 v17, v81, v17
    v_mul_f32 v18, v82, v18
    v_mul_f32 v19, v83, v19
    v_mul_f32 v20, v84, v20
    v_mul_f32 v21, v85, v21
    v_mul_f32 v22, v86, v22
    v_mul_f32 v23, v87, v23
    v_cvt_pk_bf16_f32 v24, v16, v20
    v_cvt_pk_bf16_f32 v25, v17, v21
    v_cvt_pk_bf16_f32 v26, v18, v22
    v_cvt_pk_bf16_f32 v27, v19, v23
    s_lshl_b32 s57, s53, 12
    s_add_u32 s57, s57, 147456
    s_lshl_b32 s58, s52, 2
    v_add_u32 v11, s58, v4
    v_xor_b32 v11, v11, v3
    v_lshlrev_b32 v11, 4, v11
    v_lshl_add_u32 v11, v3, 8, v11
    v_add_u32 v11, s57, v11
    ds_write_b128 v11, v[24:27]
    v_and_b32 v11, 3, v3
    v_lshlrev_b32 v11, 2, v11
    v_lshrrev_b32 v12, 2, v3
    v_add_u32 v11, v11, v12
    v_xor_b32 v12, v4, v11
    v_lshlrev_b32 v12, 4, v12
    v_lshl_add_u32 v11, v11, 8, s57
    s_waitcnt lgkmcnt(0)
    s_barrier
    v_xor_b32 v13, 0, v12
    v_add_u32 v13, v13, v11
    ds_read_b128 v[16:19], v13
    v_xor_b32 v13, 64, v12
    v_add_u32 v13, v13, v11
    ds_read_b128 v[20:23], v13
    v_xor_b32 v13, 128, v12
    v_add_u32 v13, v13, v11
    ds_read_b128 v[24:27], v13
    v_xor_b32 v13, 192, v12
    v_add_u32 v13, v13, v11
    ds_read_b128 v[28:31], v13
    s_waitcnt lgkmcnt(0)
    v_mfma_f32_16x16x32_bf16 v[80:83], v[16:19], v[32:35], 0
    v_mfma_f32_16x16x32_bf16 v[80:83], v[20:23], v[36:39], v[80:83]
    v_mfma_f32_16x16x32_bf16 v[80:83], v[24:27], v[40:43], v[80:83]
    v_mfma_f32_16x16x32_bf16 v[80:83], v[28:31], v[44:47], v[80:83]
    ds_read_b128 v[32:35], v10 offset:32768
    ds_read_b128 v[36:39], v10 offset:33792
    ds_read_b128 v[40:43], v10 offset:34816
    ds_read_b128 v[44:47], v10 offset:35840
    v_mfma_f32_16x16x32_bf16 v[84:87], v[16:19], v[48:51], 0
    v_mfma_f32_16x16x32_bf16 v[84:87], v[20:23], v[52:55], v[84:87]
    v_mfma_f32_16x16x32_bf16 v[84:87], v[24:27], v[56:59], v[84:87]
    v_mfma_f32_16x16x32_bf16 v[84:87], v[28:31], v[60:63], v[84:87]
    ds_read_b128 v[48:51], v10 offset:36864
    ds_read_b128 v[52:55], v10 offset:37888
    ds_read_b128 v[56:59], v10 offset:38912
    ds_read_b128 v[60:63], v10 offset:39936
    s_waitcnt lgkmcnt(4)
    v_mfma_f32_16x16x32_bf16 v[88:91], v[16:19], v[32:35], 0
    v_mfma_f32_16x16x32_bf16 v[88:91], v[20:23], v[36:39], v[88:91]
    v_mfma_f32_16x16x32_bf16 v[88:91], v[24:27], v[40:43], v[88:91]
    v_mfma_f32_16x16x32_bf16 v[88:91], v[28:31], v[44:47], v[88:91]
    ds_read_b128 v[32:35], v14 offset:0
    ds_read_b128 v[36:39], v14 offset:1024
    ds_read_b128 v[40:43], v14 offset:2048
    ds_read_b128 v[44:47], v14 offset:3072
    s_waitcnt lgkmcnt(4)
    v_mfma_f32_16x16x32_bf16 v[92:95], v[16:19], v[48:51], 0
    v_mfma_f32_16x16x32_bf16 v[92:95], v[20:23], v[52:55], v[92:95]
    v_mfma_f32_16x16x32_bf16 v[92:95], v[24:27], v[56:59], v[92:95]
    v_mfma_f32_16x16x32_bf16 v[92:95], v[28:31], v[60:63], v[92:95]
    ds_read_b128 v[48:51], v14 offset:4096
    ds_read_b128 v[52:55], v14 offset:5120
    ds_read_b128 v[56:59], v14 offset:6144
    ds_read_b128 v[60:63], v14 offset:7168
    s_waitcnt lgkmcnt(4)
    v_mfma_f32_16x16x32_bf16 v[96:99], v[16:19], v[32:35], 0
    v_mfma_f32_16x16x32_bf16 v[96:99], v[20:23], v[36:39], v[96:99]
    v_mfma_f32_16x16x32_bf16 v[96:99], v[24:27], v[40:43], v[96:99]
    v_mfma_f32_16x16x32_bf16 v[96:99], v[28:31], v[44:47], v[96:99]
    s_waitcnt lgkmcnt(0)
    v_mfma_f32_16x16x32_bf16 v[100:103], v[16:19], v[48:51], 0
    v_mfma_f32_16x16x32_bf16 v[100:103], v[20:23], v[52:55], v[100:103]
    v_mfma_f32_16x16x32_bf16 v[100:103], v[24:27], v[56:59], v[100:103]
    v_mfma_f32_16x16x32_bf16 v[100:103], v[28:31], v[60:63], v[100:103]
    s_mul_i32 s55, s52, 2560000
    s_add_u32 s36, s24, s55
    s_addc_u32 s37, s25, 0
    s_and_b32 s37, s37, 0xffff
    s_mov_b32 s38, 2560000
    s_mov_b32 s39, 0x00020000
    s_mul_i32 s55, s52, 640000
    s_add_u32 s40, s24, s55
    s_addc_u32 s41, s25, 0
    s_add_u32 s40, s40, 10240000
    s_addc_u32 s41, s41, 0
    s_and_b32 s41, s41, 0xffff
    s_mov_b32 s42, 640000
    s_mov_b32 s43, 0x00020000
    v_add_u32 v5, s54, v4
    v_lshlrev_b32 v6, 8, v5
    v_lshl_add_u32 v6, v3, 4, v6
    s_lshl_b32 s55, s54, 6
    v_lshl_add_u32 v7, v2, 4, s55
    s_mul_i32 s55, s26, 3072
    s_add_u32 s55, s55, 98304
    v_lshlrev_b32 v53, 6, v4
    v_lshl_add_u32 v53, v3, 2, v53
    v_add_u32 v53, s55, v53
    v_lshl_add_u32 v54, v2, 4, s55
    s_mov_b32 s57, 0xffff0000
    s_mov_b32 s58, 0x07060100
    s_mov_b32 s59, 0x07060302
    s_mov_b32 s60, 0x8000
    v_mov_b32 v8, 8388608
    v_add_f32 v16, v8, v84
    v_cvt_pk_bf16_f32 v20, v80, v80
    v_add_f32 v17, v8, v85
    v_cvt_pk_bf16_f32 v21, v81, v81
    v_add_f32 v18, v8, v86
    v_cvt_pk_bf16_f32 v22, v82, v82
    v_add_f32 v19, v8, v87
    v_cvt_pk_bf16_f32 v23, v83, v83
    v_sub_u32_sdwa v16, v16, v20 dst_sel:DWORD dst_unused:UNUSED_PAD src0_sel:DWORD src1_sel:WORD_0
    v_sub_u32_sdwa v17, v17, v21 dst_sel:DWORD dst_unused:UNUSED_PAD src0_sel:DWORD src1_sel:WORD_0
    v_sub_u32_sdwa v18, v18, v22 dst_sel:DWORD dst_unused:UNUSED_PAD src0_sel:DWORD src1_sel:WORD_0
    v_sub_u32_sdwa v19, v19, v23 dst_sel:DWORD dst_unused:UNUSED_PAD src0_sel:DWORD src1_sel:WORD_0
    v_add_u32 v16, 0x8000, v16
    v_add_u32 v17, 0x8000, v17
    v_add_u32 v18, 0x8000, v18
    v_add_u32 v19, 0x8000, v19
    v_perm_b32 v16, v16, v20, s58
    v_perm_b32 v17, v17, v21, s58
    v_perm_b32 v18, v18, v22, s58
    v_perm_b32 v19, v19, v23, s58
    ds_write_b32 v53, v16 offset:0
    ds_write_b32 v53, v17 offset:256
    ds_write_b32 v53, v18 offset:512
    ds_write_b32 v53, v19 offset:768
    s_waitcnt lgkmcnt(0)
    ds_read_b128 v[20:23], v54
    s_waitcnt lgkmcnt(0)
    buffer_store_dwordx4 v[20:23], v7, s[40:43], 0 offen sc1
    s_waitcnt vmcnt(1)
    ds_write_b128 v117, v[104:107]
    ds_write_b128 v118, v[108:111]
    ds_write_b128 v119, v[112:115]
    s_waitcnt lgkmcnt(0)
    s_barrier
    s_lshl_b32 s56, s53, 4
    v_add_u32 v5, s56, v4
    v_mul_u32_u24 v9, 768, v5
    v_and_b32 v5, 1, v5
    v_xor_b32 v5, s52, v5
    v_lshlrev_b32 v5, 6, v5
    v_add_u32 v9, v9, v5
    v_lshl_add_u32 v9, v3, 2, v9
    v_add_u32 v9, 98304, v9
    ds_read_b32 v104, v9 offset:0
    ds_read_b32 v108, v9 offset:256
    ds_read_b32 v112, v9 offset:512
    ds_read_b32 v105, v9 offset:3072
    ds_read_b32 v109, v9 offset:3328
    ds_read_b32 v113, v9 offset:3584
    ds_read_b32 v106, v9 offset:6144
    ds_read_b32 v110, v9 offset:6400
    ds_read_b32 v114, v9 offset:6656
    ds_read_b32 v107, v9 offset:9216
    ds_read_b32 v111, v9 offset:9472
    ds_read_b32 v115, v9 offset:9728
    v_readfirstlane_b32 s101, v116
    s_waitcnt lgkmcnt(0)
    v_lshlrev_b32 v32, 16, v104
    v_and_b32 v33, 0xffff0000, v104
    v_lshlrev_b32 v34, 16, v108
    v_and_b32 v35, 0xffff0000, v108
    v_lshlrev_b32 v36, 16, v112
    v_and_b32 v37, 0xffff0000, v112
    v_fma_f32 v38, v88, v32, v8
    v_fma_f32 v39, v92, v33, v8
    v_fma_f32 v40, v88, v34, v8
    v_fma_f32 v41, v92, v35, v8
    v_fma_f32 v42, v88, v36, v8
    v_fma_f32 v43, v92, v37, v8
    v_cvt_pk_bf16_f32 v45, v42, v96
    v_cvt_pk_bf16_f32 v46, v43, v100
    v_sub_u32_sdwa v48, v38, v45 dst_sel:DWORD dst_unused:UNUSED_PAD src0_sel:DWORD src1_sel:WORD_0
    v_add_u32 v48, 0x8000, v48
    v_perm_b32 v16, v48, v45, s58
    v_sub_u32_sdwa v49, v40, v45 dst_sel:DWORD dst_unused:UNUSED_PAD src0_sel:DWORD src1_sel:WORD_1
    v_add_u32 v49, 0x8000, v49
    v_perm_b32 v17, v49, v45, s59
    v_sub_u32_sdwa v50, v39, v46 dst_sel:DWORD dst_unused:UNUSED_PAD src0_sel:DWORD src1_sel:WORD_0
    v_add_u32 v50, 0x8000, v50
    v_perm_b32 v18, v50, v46, s58
    v_sub_u32_sdwa v51, v41, v46 dst_sel:DWORD dst_unused:UNUSED_PAD src0_sel:DWORD src1_sel:WORD_1
    v_add_u32 v51, 0x8000, v51
    v_perm_b32 v19, v51, v46, s59
    buffer_store_dwordx4 v[16:19], v6, s[36:39], 0 offen offset:0 sc1
    v_lshlrev_b32 v32, 16, v105
    v_and_b32 v33, 0xffff0000, v105
    v_lshlrev_b32 v34, 16, v109
    v_and_b32 v35, 0xffff0000, v109
    v_lshlrev_b32 v36, 16, v113
    v_and_b32 v37, 0xffff0000, v113
    v_fma_f32 v38, v89, v32, v8
    v_fma_f32 v39, v93, v33, v8
    v_fma_f32 v40, v89, v34, v8
    v_fma_f32 v41, v93, v35, v8
    v_fma_f32 v42, v89, v36, v8
    v_fma_f32 v43, v93, v37, v8
    v_cvt_pk_bf16_f32 v45, v42, v97
    v_cvt_pk_bf16_f32 v46, v43, v101
    v_sub_u32_sdwa v48, v38, v45 dst_sel:DWORD dst_unused:UNUSED_PAD src0_sel:DWORD src1_sel:WORD_0
    v_add_u32 v48, 0x8000, v48
    v_perm_b32 v24, v48, v45, s58
    v_sub_u32_sdwa v49, v40, v45 dst_sel:DWORD dst_unused:UNUSED_PAD src0_sel:DWORD src1_sel:WORD_1
    v_add_u32 v49, 0x8000, v49
    v_perm_b32 v25, v49, v45, s59
    v_sub_u32_sdwa v50, v39, v46 dst_sel:DWORD dst_unused:UNUSED_PAD src0_sel:DWORD src1_sel:WORD_0
    v_add_u32 v50, 0x8000, v50
    v_perm_b32 v26, v50, v46, s58
    v_sub_u32_sdwa v51, v41, v46 dst_sel:DWORD dst_unused:UNUSED_PAD src0_sel:DWORD src1_sel:WORD_1
    v_add_u32 v51, 0x8000, v51
    v_perm_b32 v27, v51, v46, s59
    buffer_store_dwordx4 v[24:27], v6, s[36:39], 0 offen offset:1024 sc1
    v_lshlrev_b32 v32, 16, v106
    v_and_b32 v33, 0xffff0000, v106
    v_lshlrev_b32 v34, 16, v110
    v_and_b32 v35, 0xffff0000, v110
    v_lshlrev_b32 v36, 16, v114
    v_and_b32 v37, 0xffff0000, v114
    v_fma_f32 v38, v90, v32, v8
    v_fma_f32 v39, v94, v33, v8
    v_fma_f32 v40, v90, v34, v8
    v_fma_f32 v41, v94, v35, v8
    v_fma_f32 v42, v90, v36, v8
    v_fma_f32 v43, v94, v37, v8
    v_cvt_pk_bf16_f32 v45, v42, v98
    v_cvt_pk_bf16_f32 v46, v43, v102
    v_sub_u32_sdwa v48, v38, v45 dst_sel:DWORD dst_unused:UNUSED_PAD src0_sel:DWORD src1_sel:WORD_0
    v_add_u32 v48, 0x8000, v48
    v_perm_b32 v16, v48, v45, s58
    v_sub_u32_sdwa v49, v40, v45 dst_sel:DWORD dst_unused:UNUSED_PAD src0_sel:DWORD src1_sel:WORD_1
    v_add_u32 v49, 0x8000, v49
    v_perm_b32 v17, v49, v45, s59
    v_sub_u32_sdwa v50, v39, v46 dst_sel:DWORD dst_unused:UNUSED_PAD src0_sel:DWORD src1_sel:WORD_0
    v_add_u32 v50, 0x8000, v50
    v_perm_b32 v18, v50, v46, s58
    v_sub_u32_sdwa v51, v41, v46 dst_sel:DWORD dst_unused:UNUSED_PAD src0_sel:DWORD src1_sel:WORD_1
    v_add_u32 v51, 0x8000, v51
    v_perm_b32 v19, v51, v46, s59
    buffer_store_dwordx4 v[16:19], v6, s[36:39], 0 offen offset:2048 sc1
    v_lshlrev_b32 v32, 16, v107
    v_and_b32 v33, 0xffff0000, v107
    v_lshlrev_b32 v34, 16, v111
    v_and_b32 v35, 0xffff0000, v111
    v_lshlrev_b32 v36, 16, v115
    v_and_b32 v37, 0xffff0000, v115
    v_fma_f32 v38, v91, v32, v8
    v_fma_f32 v39, v95, v33, v8
    v_fma_f32 v40, v91, v34, v8
    v_fma_f32 v41, v95, v35, v8
    v_fma_f32 v42, v91, v36, v8
    v_fma_f32 v43, v95, v37, v8
    v_cvt_pk_bf16_f32 v45, v42, v99
    v_cvt_pk_bf16_f32 v46, v43, v103
    v_sub_u32_sdwa v48, v38, v45 dst_sel:DWORD dst_unused:UNUSED_PAD src0_sel:DWORD src1_sel:WORD_0
    v_add_u32 v48, 0x8000, v48
    v_perm_b32 v24, v48, v45, s58
    v_sub_u32_sdwa v49, v40, v45 dst_sel:DWORD dst_unused:UNUSED_PAD src0_sel:DWORD src1_sel:WORD_1
    v_add_u32 v49, 0x8000, v49
    v_perm_b32 v25, v49, v45, s59
    v_sub_u32_sdwa v50, v39, v46 dst_sel:DWORD dst_unused:UNUSED_PAD src0_sel:DWORD src1_sel:WORD_0
    v_add_u32 v50, 0x8000, v50
    v_perm_b32 v26, v50, v46, s58
    v_sub_u32_sdwa v51, v41, v46 dst_sel:DWORD dst_unused:UNUSED_PAD src0_sel:DWORD src1_sel:WORD_1
    v_add_u32 v51, 0x8000, v51
    v_perm_b32 v27, v51, v46, s59
    buffer_store_dwordx4 v[24:27], v6, s[36:39], 0 offen offset:3072 sc1
    s_mov_b32 s100, 65536
    s_branch PH2
PH2:
    s_and_b32 s27, s2, 3
    s_lshr_b32 s3, s2, 3
    s_lshl_b32 s3, s3, 1
    s_bfe_u32 s61, s2, 0x10002
    s_add_u32 s61, s61, s3
    v_and_b32 v1, 63, v0
    v_and_b32 v2, 15, v1
    v_lshrrev_b32 v3, 4, v1
    s_mov_b32 s56, s18
    s_and_b32 s57, s19, 0xffff
    s_mov_b32 s58, 12288
    s_mov_b32 s59, 0x00020000
    s_lshl_b32 s3, s27, 6
    v_mul_u32_u24 v10, 1366, v0
    v_lshrrev_b32 v10, 16, v10
    v_mul_u32_u24 v11, 48, v10
    v_sub_u32 v11, v0, v11
    v_lshrrev_b32 v12, 4, v11
    v_and_b32 v11, 15, v11
    v_mul_u32_u24 v10, 768, v10
    v_lshl_add_u32 v10, v12, 8, v10
    v_lshl_add_u32 v10, v11, 2, v10
    v_add_u32 v10, s3, v10
    buffer_load_dword v36, v10, s[56:59], 0 offen
    s_mul_i32 s3, s61, 2564096
    s_add_u32 s36, s24, s3
    s_addc_u32 s37, s25, 0
    s_add_u32 s36, s36, 14155776
    s_addc_u32 s37, s37, 0
    s_and_b32 s37, s37, 0xffff
    s_mov_b32 s38, 2564096
    s_mov_b32 s39, 0x00020000
    s_add_u32 s44, s24, 12800000
    s_addc_u32 s45, s25, 0
    s_and_b32 s45, s45, 0xffff
    s_mov_b32 s46, 65536
    s_mov_b32 s47, 0x00020000
    s_mul_i32 s3, s27, 2560000
    s_add_u32 s28, s24, s3
    s_addc_u32 s29, s25, 0
    s_and_b32 s29, s29, 0xffff
    s_or_b32 s29, s29, 1048576
    s_mov_b32 s30, 160000
    s_mov_b32 s31, 0x00020000
    s_mul_i32 s3, s27, 640000
    s_add_u32 s32, s24, s3
    s_addc_u32 s33, s25, 0
    s_add_u32 s32, s32, 10240000
    s_addc_u32 s33, s33, 0
    s_and_b32 s33, s33, 0xffff
    s_or_b32 s33, s33, 262144
    s_mov_b32 s34, 160000
    s_mov_b32 s35, 0x00020000
    s_mul_i32 s3, s61, 160
    s_mul_i32 s62, s26, 10
    s_add_u32 s3, s3, s62
    s_add_u32 s62, s3, 10
    s_min_u32 s62, s62, 10000
    s_lshl_b32 s62, s62, 10
    s_mov_b32 s48, s4
    s_and_b32 s49, s5, 0xffff
    s_mov_b32 s50, 0
    s_mov_b32 s51, 0x00020000
    s_mov_b32 s50, s62
    s_mov_b32 s52, s20
    s_and_b32 s53, s21, 0xffff
    s_mov_b32 s54, 0
    s_mov_b32 s55, 0x00020000
    s_mov_b32 s54, s62
    s_lshl_b32 s3, s3, 10
    s_lshl_b32 s62, s27, 6
    s_add_u32 s40, s3, s62
    v_lshlrev_b32 v8, 2, v0
    v_add_u32 v8, 151552, v8
    v_mov_b32 v9, 0
    v_cmp_gt_u32 vcc, 17, v0
s_nop 0
    s_and_saveexec_b64 s[62:63], vcc
    ds_write_b32 v8, v9
    s_mov_b64 exec, s[62:63]
    s_cmp_lg_u32 s26, 0
    s_cbranch_scc1 P2_nochk
    s_mov_b32 s63, 0
    s_cmp_eq_u32 s100, 1
    s_cbranch_scc1 P2_setflag
    s_add_u32 s56, s24, 13160448
    s_addc_u32 s57, s25, 0
    s_and_b32 s57, s57, 0xffff
    s_mov_b32 s58, 4096
    s_mov_b32 s59, 0x00020000
    s_and_b32 s62, s2, 31
    s_lshl_b32 s62, s62, 7
    v_mov_b32 v6, s62
    buffer_load_dword v7, v6, s[56:59], 0 offen sc1
    s_waitcnt vmcnt(0)
    v_readfirstlane_b32 s62, v7
    s_nop 3
    s_and_b32 s62, s62, 0xffff
    s_cmp_ge_u32 s62, 95
    s_cselect_b32 s63, 1, 0
    s_cmp_lg_u32 s101, 0
    s_cselect_b32 s63, s63, 0
    s_cmp_eq_u32 s63, 0
    s_cbranch_scc1 P2_setflag
    s_lshl_b32 s3, s61, 2
    v_mov_b32 v6, s3
    buffer_load_dword v7, v6, s[96:99], 0 offen sc1
    s_waitcnt vmcnt(0)
P2_setflag:
    v_mov_b32 v6, s63
    v_mov_b32 v8, 151680
    ds_write_b64 v8, v[6:7]
P2_nochk:
    v_lshlrev_b32 v11, 2, v0
    v_add_u32 v11, 147456, v11
    s_mov_b32 s66, 0
    s_waitcnt vmcnt(0)
    v_cmp_gt_u32 vcc, 768, v0
s_nop 0
    s_and_saveexec_b64 s[62:63], vcc
    ds_write_b32 v11, v36
    s_mov_b64 exec, s[62:63]
    s_waitcnt lgkmcnt(0)
    s_barrier
    s_cmp_lg_u32 s26, 0
    s_cbranch_scc1 ARR_done
    s_cmp_lg_u32 s101, 0
    s_cbranch_scc1 ARR_zok
    v_mov_b32 v6, 252
    s_mov_b32 s62, 0
ARR_zpoll:
    buffer_load_dword v7, v6, s[96:99], 0 offen sc1
    s_waitcnt vmcnt(0)
    v_readfirstlane_b32 s101, v7
    s_add_u32 s62, s62, 1
    s_cmp_ge_u32 s62, 0x40000
    s_cbranch_scc1 ARR_zok
    s_cmp_lg_u32 s101, 0
    s_cbranch_scc1 ARR_zok
    s_sleep 8
    s_branch ARR_zpoll
ARR_zok:
    s_add_u32 s56, s24, 13160448
    s_addc_u32 s57, s25, 0
    s_and_b32 s57, s57, 0xffff
    s_mov_b32 s58, 4096
    s_mov_b32 s59, 0x00020000
    v_mov_b32 v6, s100
    v_lshlrev_b32 v7, 7, v0
    buffer_atomic_add v6, v7, s[56:59], 0 offen
ARR_done:
    s_cmp_lg_u32 s66, 0
    s_cbranch_scc1 P2_loaded
    v_mov_b32 v8, 151680
    ds_read_b64 v[30:31], v8
    s_waitcnt lgkmcnt(0)
    v_readfirstlane_b32 s62, v30
    v_readfirstlane_b32 s64, v31
    s_nop 3
    s_cmp_lg_u32 s62, 0
    s_cbranch_scc1 P2_bok
    s_cmp_lg_u32 s26, 0
    s_cbranch_scc1 POLLB_done
    s_add_u32 s56, s24, 13160448
    s_addc_u32 s57, s25, 0
    s_and_b32 s57, s57, 0xffff
    s_mov_b32 s58, 4096
    s_mov_b32 s59, 0x00020000
    s_and_b32 s62, s2, 31
    s_lshl_b32 s62, s62, 7
    v_mov_b32 v6, s62
    s_mov_b32 s62, 0
POLLB_loop:
    buffer_load_dword v7, v6, s[56:59], 0 offen sc1
    s_waitcnt vmcnt(0)
    v_readfirstlane_b32 s63, v7
    s_add_u32 s62, s62, 1
    s_nop 2
    s_and_b32 s63, s63, 0xffff
    s_cmp_ge_u32 s63, 95
    s_cbranch_scc1 POLLB_done
    s_cmp_ge_u32 s62, 0x40000
    s_cbranch_scc1 POLLB_done
    s_sleep 4
    s_branch POLLB_loop
POLLB_done:
    s_cmp_lg_u32 s26, 0
    s_cbranch_scc1 P2_cnt2
    s_lshl_b32 s3, s61, 2
    v_mov_b32 v6, s3
    buffer_load_dword v7, v6, s[96:99], 0 offen sc1
    v_mov_b32 v8, 151680
    s_waitcnt vmcnt(0)
    ds_write_b32 v8, v7 offset:8
    s_waitcnt lgkmcnt(0)
P2_cnt2:
    s_barrier
    v_mov_b32 v8, 151680
    ds_read_b32 v31, v8 offset:8
    s_waitcnt lgkmcnt(0)
    v_readfirstlane_b32 s64, v31
P2_bok:
s_nop 0
    s_min_u32 s64, s64, 160256
    s_lshl_b32 s38, s64, 4
    v_lshlrev_b32 v6, 4, v0
    v_add_u32 v7, 0x4000, v6
    buffer_load_dwordx4 v[16:19], v6, s[36:39], 0 offen sc1
    buffer_load_dwordx4 v[20:23], v7, s[36:39], 0 offen sc1
    v_add_u32 v10, 0x8000, v6
    v_add_u32 v11, 0xc000, v6
    buffer_load_dwordx4 v[84:87], v6, s[44:47], 0 offen sc1
    buffer_load_dwordx4 v[88:91], v7, s[44:47], 0 offen sc1
    buffer_load_dwordx4 v[92:95], v10, s[44:47], 0 offen sc1
    buffer_load_dwordx4 v[76:79], v11, s[44:47], 0 offen sc1
P2_loaded:
    s_mov_b32 s65, 0
    s_movk_i32 s43, 2048
    s_mov_b32 s41, 0
    v_sub_u32 v4, 15, v2
    v_lshl_or_b32 v4, v4, 16, v4
    v_lshlrev_b32 v5, 3, v3
    s_mov_b32 s66, 1
    s_mov_b32 s67, 0
    s_waitcnt vmcnt(4)
    s_min_u32 s64, s64, 160256
    s_nop 0
    s_branch K2_have_rec
K2_chunk:
    s_nop 0
    s_mov_b32 s66, 0
    v_mbcnt_lo_u32_b32 v1, -1, 0
    v_mbcnt_hi_u32_b32 v1, -1, v1
    s_lshl_b32 s3, s26, 6
    v_add_u32 v0, s3, v1
    v_lshrrev_b32 v3, 4, v1
    v_and_b32 v2, 15, v1
    v_sub_u32 v4, 15, v2
    v_lshl_or_b32 v4, v4, 16, v4
    v_lshlrev_b32 v5, 3, v3
    v_add_u32 v6, s65, v0
    v_lshlrev_b32 v6, 4, v6
    v_add_u32 v7, 0x4000, v6
    buffer_load_dwordx4 v[16:19], v6, s[36:39], 0 offen sc1
    buffer_load_dwordx4 v[20:23], v7, s[36:39], 0 offen sc1
    v_lshlrev_b32 v8, 2, v0
    v_add_u32 v8, 151552, v8
    v_mov_b32 v9, 0
    v_cmp_gt_u32 vcc, 17, v0
s_nop 0
    s_and_saveexec_b64 s[62:63], vcc
    ds_write_b32 v8, v9
    s_mov_b64 exec, s[62:63]
    s_waitcnt vmcnt(0) lgkmcnt(0)
    s_barrier
K2_have_rec:
    s_sub_u32 s70, s64, s65
    s_min_u32 s70, s70, s43
    v_add_u32 v10, 1024, v0
    v_cmp_gt_u32 s[72:73], s70, v0
    v_cmp_gt_u32 s[74:75], s70, v10
    v_mov_b32 v9, 1
    v_cmp_ne_u32 vcc, -1, v16
    v_and_b32 v26, 15, v16
    s_and_b64 s[72:73], s[72:73], vcc
    v_cmp_ne_u32 vcc, -1, v20
    v_and_b32 v27, 15, v20
    s_and_b64 s[74:75], s[74:75], vcc
    v_lshlrev_b32 v26, 2, v26
    v_add_u32 v26, 151552, v26
    s_mov_b64 exec, s[72:73]
    ds_add_rtn_u32 v24, v26, v9
    s_mov_b64 exec, -1
    v_lshlrev_b32 v27, 2, v27
    v_add_u32 v27, 151552, v27
    s_mov_b64 exec, s[74:75]
    ds_add_rtn_u32 v25, v27, v9
    s_mov_b64 exec, -1
    v_and_b32 v16, -16, v16
    v_and_b32 v20, -16, v20
    v_mov_b32 v11, 151616
    s_waitcnt lgkmcnt(1)
    v_lshrrev_b32 v10, 2, v24
    v_mul_u32_u24 v10, 80, v10
    v_lshrrev_b32 v12, 16, v19
    v_add_u32 v10, v10, v12
    v_and_b32 v14, 3, v24
    v_add_u32 v10, 65536, v10
    v_cmp_le_u32 vcc, 192, v24
    v_lshl_add_u32 v15, v14, 2, v10
    v_lshl_add_u32 v10, v14, 1, v10
    s_and_b64 s[62:63], s[72:73], vcc
    s_andn2_b64 exec, s[72:73], vcc
    ds_write_b32 v15, v16
    ds_write_b16 v10, v17 offset:48
    ds_write_b16_d16_hi v10, v17 offset:24
    ds_write_b16 v10, v18 offset:32
    ds_write_b16_d16_hi v10, v18 offset:16
    ds_write_b16 v10, v19 offset:40
    s_mov_b64 exec, s[62:63]
    ds_write_b32 v11, v9
    s_mov_b64 exec, -1
    s_waitcnt lgkmcnt(0)
    v_lshrrev_b32 v10, 2, v25
    v_mul_u32_u24 v10, 80, v10
    v_lshrrev_b32 v12, 16, v23
    v_add_u32 v10, v10, v12
    v_and_b32 v14, 3, v25
    v_add_u32 v10, 65536, v10
    v_cmp_le_u32 vcc, 192, v25
    v_lshl_add_u32 v15, v14, 2, v10
    v_lshl_add_u32 v10, v14, 1, v10
    s_and_b64 s[62:63], s[74:75], vcc
    s_andn2_b64 exec, s[74:75], vcc
    ds_write_b32 v15, v20
    ds_write_b16 v10, v21 offset:48
    ds_write_b16_d16_hi v10, v21 offset:24
    ds_write_b16 v10, v22 offset:32
    ds_write_b16_d16_hi v10, v22 offset:16
    ds_write_b16 v10, v23 offset:40
    s_mov_b64 exec, s[62:63]
    ds_write_b32 v11, v9
    s_mov_b64 exec, -1
    s_cmp_eq_u32 s66, 0
    s_cbranch_scc1 K2_nopoll
    s_add_u32 s56, s24, 13160448
    s_addc_u32 s57, s25, 0
    s_and_b32 s57, s57, 0xffff
    s_mov_b32 s58, 4096
    s_mov_b32 s59, 0x00020000
    s_and_b32 s62, s2, 31
    s_lshl_b32 s62, s62, 7
    s_cmp_lg_u32 s26, 0
    s_cselect_b32 s62, 0x10000, s62
    v_mov_b32 v83, s62
    buffer_load_dword v83, v83, s[56:59], 0 offen sc1
    s_waitcnt lgkmcnt(0)
    s_cmp_lg_u32 s26, 0
    s_cbranch_scc1 POLLA_done
    s_waitcnt vmcnt(0)
    v_readfirstlane_b32 s63, v83
    s_nop 3
    s_lshr_b32 s63, s63, 16
    s_cmp_ge_u32 s63, 157
    s_cbranch_scc1 POLLA_done
    s_cmp_lg_u32 s26, 0
    s_cbranch_scc1 POLLA_done
    s_add_u32 s56, s24, 13160448
    s_addc_u32 s57, s25, 0
    s_and_b32 s57, s57, 0xffff
    s_mov_b32 s58, 4096
    s_mov_b32 s59, 0x00020000
    s_and_b32 s62, s2, 31
    s_lshl_b32 s62, s62, 7
    v_mov_b32 v10, s62
    s_mov_b32 s62, 0
POLLA_loop:
    buffer_load_dword v11, v10, s[56:59], 0 offen sc1
    s_waitcnt vmcnt(0)
    v_readfirstlane_b32 s63, v11
    s_add_u32 s62, s62, 1
    s_nop 2
    s_lshr_b32 s63, s63, 16
    s_cmp_ge_u32 s63, 157
    s_cbranch_scc1 POLLA_done
    s_cmp_ge_u32 s62, 0x40000
    s_cbranch_scc1 POLLA_done
    s_sleep 4
    s_branch POLLA_loop
POLLA_done:
    s_barrier
    s_branch K2_go
K2_nopoll:
    s_waitcnt lgkmcnt(0)
    s_barrier
K2_go:
    s_waitcnt vmcnt(0)
    v_lshlrev_b32 v9, 4, v0
    s_lshl_b32 s62, s26, 2
    s_add_u32 s62, s62, 151552
    v_mov_b32 v10, s62
    v_mov_b32 v11, 151616
    ds_read_b32 v12, v10
    ds_read_b32 v13, v11
    s_waitcnt lgkmcnt(0)
    v_readfirstlane_b32 s42, v12
    v_readfirstlane_b32 s63, v13
    s_nop 3
    s_cmp_eq_u32 s63, 0
    s_cbranch_scc1 K2_noovf
    s_movk_i32 s43, 192
    s_cmp_eq_u32 s66, 0
    s_cbranch_scc1 K2_lw_o
    ds_write_b128 v9, v[84:87]
    ds_write_b128 v9, v[88:91] offset:16384
    ds_write_b128 v9, v[92:95] offset:32768
    ds_write_b128 v9, v[76:79] offset:49152
    s_waitcnt lgkmcnt(0)
    s_barrier
K2_lw_o:
    s_cmp_lg_u32 s67, 0
    s_cbranch_scc1 K2_init_o
    s_mov_b32 s67, 1
    v_mul_u32_u24 v48, 96, v5
    v_lshl_add_u32 v48, v2, 2, v48
    v_add_u32 v48, 147456, v48
    ds_read_b32 v36, v48 offset:0
    ds_read_b32 v37, v48 offset:192
    ds_read_b32 v38, v48 offset:384
    ds_read_b32 v39, v48 offset:576
    ds_read_b32 v40, v48 offset:64
    ds_read_b32 v41, v48 offset:256
    ds_read_b32 v42, v48 offset:448
    ds_read_b32 v43, v48 offset:640
    ds_read_b32 v44, v48 offset:128
    ds_read_b32 v45, v48 offset:320
    ds_read_b32 v46, v48 offset:512
    ds_read_b32 v47, v48 offset:704
    v_mov_b32 v96, 0
    v_mov_b32 v97, 0
    v_mov_b32 v98, 0
    v_mov_b32 v99, 0
    v_mov_b32 v100, 0
    v_mov_b32 v101, 0
    v_mov_b32 v102, 0
    v_mov_b32 v103, 0
    v_mov_b32 v104, 0
    v_mov_b32 v105, 0
    v_mov_b32 v106, 0
    v_mov_b32 v107, 0
    v_mov_b32 v108, 0
    v_mov_b32 v109, 0
    v_mov_b32 v110, 0
    v_mov_b32 v111, 0
    v_mov_b32 v112, 0
    v_mov_b32 v113, 0
    v_mov_b32 v114, 0
    v_mov_b32 v115, 0
    v_mov_b32 v116, 0
    v_mov_b32 v117, 0
    v_mov_b32 v118, 0
    v_mov_b32 v119, 0
    v_mov_b32 v120, 0
    v_mov_b32 v121, 0
    v_mov_b32 v122, 0
    v_mov_b32 v123, 0
    v_mov_b32 v124, 0
    v_mov_b32 v125, 0
    v_mov_b32 v126, 0
    v_mov_b32 v127, 0
    s_mov_b32 s62, 0x05040100
    s_mov_b32 s63, 0x07060302
    s_waitcnt lgkmcnt(0)
    v_perm_b32 v84, v37, v36, s62
    v_perm_b32 v85, v39, v38, s62
    v_perm_b32 v86, v37, v36, s63
    v_perm_b32 v87, v39, v38, s63
    v_perm_b32 v88, v41, v40, s62
    v_perm_b32 v89, v43, v42, s62
    v_perm_b32 v90, v41, v40, s63
    v_perm_b32 v91, v43, v42, s63
    v_perm_b32 v92, v45, v44, s62
    v_perm_b32 v93, v47, v46, s62
    v_perm_b32 v94, v45, v44, s63
    v_perm_b32 v95, v47, v46, s63
K2_init_o:
    s_barrier
    s_branch K2_chunk
K2_noovf:
    s_add_u32 s71, s42, 15
    s_and_b32 s71, s71, -16
    v_add_u32 v10, s42, v1
    v_cmp_gt_u32 vcc, s71, v10
    s_mul_i32 s60, s26, 3840
    s_add_u32 s60, s60, 65536
    v_and_b32 v14, 3, v10
    v_lshrrev_b32 v11, 2, v10
    v_mul_u32_u24 v11, 80, v11
    v_add_u32 v11, s60, v11
    v_lshl_add_u32 v15, v14, 2, v11
    v_lshl_add_u32 v11, v14, 1, v11
    v_mov_b32 v12, 0x7ffffff0
    v_mov_b32 v13, 0
    s_and_saveexec_b64 s[62:63], vcc
    ds_write_b32 v15, v12
    ds_write_b16 v11, v13 offset:48
    ds_write_b16 v11, v13 offset:24
    s_mov_b64 exec, s[62:63]
    s_lshr_b32 s71, s71, 4
    v_mul_u32_u24 v10, 80, v3
    v_add_u32 v10, s60, v10
    v_lshrrev_b32 v11, 2, v2
    v_mul_u32_u24 v11, 80, v11
    v_and_b32 v8, 3, v2
    v_lshl_add_u32 v11, v8, 1, v11
    v_add_u32 v11, s60, v11
    v_mov_b32 v0, v2
    v_mov_b32 v1, v4
    v_mov_b32 v2, v5
    v_mov_b32 v3, v10
    v_mov_b32 v4, v11
    s_cmp_eq_u32 s71, 0
    s_cbranch_scc1 K2_noload
    ds_read_b128 v[62:65], v3
    ds_read_u16 v5, v4 offset:48
    ds_read_b128 v[66:69], v3 offset:16
    ds_read_b64 v[70:71], v3 offset:32
    ds_read_b64 v[74:75], v3 offset:40
    s_waitcnt lgkmcnt(3)
    v_add_u32 v62, v62, v0
    v_add_u32 v63, v63, v0
    v_add_u32 v64, v64, v0
    v_add_u32 v65, v65, v0
    buffer_load_dwordx4 v[16:19], v62, s[28:31], 0 idxen sc1
    buffer_load_dwordx4 v[20:23], v63, s[28:31], 0 idxen sc1
    buffer_load_dwordx4 v[24:27], v64, s[28:31], 0 idxen sc1
    buffer_load_dwordx4 v[28:31], v65, s[28:31], 0 idxen sc1
    buffer_load_dword v32, v62, s[32:35], 0 idxen sc1
    buffer_load_dword v33, v63, s[32:35], 0 idxen sc1
    buffer_load_dword v34, v64, s[32:35], 0 idxen sc1
    buffer_load_dword v35, v65, s[32:35], 0 idxen sc1
K2_noload:
    s_cmp_eq_u32 s66, 0
    s_cbranch_scc1 K2_lw_m
    ds_write_b128 v9, v[84:87]
    ds_write_b128 v9, v[88:91] offset:16384
    ds_write_b128 v9, v[92:95] offset:32768
    ds_write_b128 v9, v[76:79] offset:49152
    s_waitcnt lgkmcnt(0)
    s_barrier
K2_lw_m:
    s_cmp_eq_u32 s71, 0
    s_cbranch_scc1 K2_chunk_end
    v_add_u32 v5, v5, v2
    ds_read_b128 v[62:65], v3 offset:320
    ds_read_b64 v[6:7], v5
    s_cmp_lg_u32 s67, 0
    s_cbranch_scc1 K2_init_m
    s_mov_b32 s67, 1
    v_mul_u32_u24 v48, 96, v2
    v_lshl_add_u32 v48, v0, 2, v48
    v_add_u32 v48, 147456, v48
    ds_read_b32 v36, v48 offset:0
    ds_read_b32 v37, v48 offset:192
    ds_read_b32 v38, v48 offset:384
    ds_read_b32 v39, v48 offset:576
    ds_read_b32 v40, v48 offset:64
    ds_read_b32 v41, v48 offset:256
    ds_read_b32 v42, v48 offset:448
    ds_read_b32 v43, v48 offset:640
    ds_read_b32 v44, v48 offset:128
    ds_read_b32 v45, v48 offset:320
    ds_read_b32 v46, v48 offset:512
    ds_read_b32 v47, v48 offset:704
    v_mov_b32 v96, 0
    v_mov_b32 v97, 0
    v_mov_b32 v98, 0
    v_mov_b32 v99, 0
    v_mov_b32 v100, 0
    v_mov_b32 v101, 0
    v_mov_b32 v102, 0
    v_mov_b32 v103, 0
    v_mov_b32 v104, 0
    v_mov_b32 v105, 0
    v_mov_b32 v106, 0
    v_mov_b32 v107, 0
    v_mov_b32 v108, 0
    v_mov_b32 v109, 0
    v_mov_b32 v110, 0
    v_mov_b32 v111, 0
    v_mov_b32 v112, 0
    v_mov_b32 v113, 0
    v_mov_b32 v114, 0
    v_mov_b32 v115, 0
    v_mov_b32 v116, 0
    v_mov_b32 v117, 0
    v_mov_b32 v118, 0
    v_mov_b32 v119, 0
    v_mov_b32 v120, 0
    v_mov_b32 v121, 0
    v_mov_b32 v122, 0
    v_mov_b32 v123, 0
    v_mov_b32 v124, 0
    v_mov_b32 v125, 0
    v_mov_b32 v126, 0
    v_mov_b32 v127, 0
    s_mov_b32 s62, 0x05040100
    s_mov_b32 s63, 0x07060302
    s_waitcnt lgkmcnt(0)
    v_perm_b32 v84, v37, v36, s62
    v_perm_b32 v85, v39, v38, s62
    v_perm_b32 v86, v37, v36, s63
    v_perm_b32 v87, v39, v38, s63
    v_perm_b32 v88, v41, v40, s62
    v_perm_b32 v89, v43, v42, s62
    v_perm_b32 v90, v41, v40, s63
    v_perm_b32 v91, v43, v42, s63
    v_perm_b32 v92, v45, v44, s62
    v_perm_b32 v93, v47, v46, s62
    v_perm_b32 v94, v45, v44, s63
    v_perm_b32 v95, v47, v46, s63
K2_init_m:
    ds_read_u16 v5, v4 offset:368
    s_cmp_eq_u32 s71, 1
    s_cbranch_scc1 K2_B0L
K2_B0N:
    s_cmp_ge_u32 s71, 6
    s_cbranch_scc1 K2_p30N
    s_cmp_ge_u32 s71, 4
    s_cbranch_scc1 K2_p20N
    s_setprio 1
    s_branch K2_pd0N
K2_p30N:
    s_setprio 3
    s_branch K2_pd0N
K2_p20N:
    s_setprio 2
K2_pd0N:
    s_waitcnt lgkmcnt(1)
    v_mfma_f32_16x16x16_bf16 v[40:43], v[6:7], v[88:89], 0
    v_mfma_f32_16x16x16_bf16 v[44:47], v[6:7], v[92:93], 0
    v_mfma_f32_16x16x16_bf16 v[36:39], v[6:7], v[84:85], 0
    v_add_u32 v62, v62, v0
    v_add_u32 v63, v63, v0
    v_add_u32 v64, v64, v0
    v_add_u32 v65, v65, v0
    buffer_load_dwordx4 v[8:11], v62, s[28:31], 0 idxen sc1
    buffer_load_dwordx4 v[12:15], v63, s[28:31], 0 idxen sc1
    buffer_load_dwordx4 v[76:79], v64, s[28:31], 0 idxen sc1
    buffer_load_dwordx4 v[80:83], v65, s[28:31], 0 idxen sc1
    v_pk_lshlrev_b16 v50, v1, v68
    v_pk_lshlrev_b16 v51, v1, v69
    v_pk_ashrrev_i16 v50, 15, v50 op_sel_hi:[0,1]
    v_pk_ashrrev_i16 v51, 15, v51 op_sel_hi:[0,1]
    v_and_b32 v66, v50, v66
    v_and_b32 v70, v50, v70
    v_and_b32 v74, v50, v74
    v_and_b32 v68, 0x3f803f80, v50
    v_and_b32 v72, 0x3f803f80, v50
    v_and_b32 v67, v51, v67
    v_and_b32 v71, v51, v71
    v_and_b32 v75, v51, v75
    v_and_b32 v69, 0x3f803f80, v51
    v_and_b32 v73, 0x3f803f80, v51
    s_waitcnt vmcnt(8)
    v_lshlrev_b32 v52, 16, v17
    v_lshlrev_b32 v53, 16, v21
    v_lshlrev_b32 v54, 16, v25
    v_lshlrev_b32 v55, 16, v29
    v_mul_f32 v48, v16, v40
    v_mul_f32 v49, v20, v41
    v_mul_f32 v50, v24, v42
    v_mul_f32 v51, v28, v43
    v_mul_f32 v52, v52, v44
    v_mul_f32 v53, v53, v45
    v_mul_f32 v54, v54, v46
    v_mul_f32 v55, v55, v47
    v_cvt_pk_bf16_f32 v56, v48, v49
    v_cvt_pk_bf16_f32 v57, v50, v51
    v_mul_f32 v48, v17, v40
    v_mul_f32 v49, v21, v41
    v_mul_f32 v50, v25, v42
    v_mul_f32 v51, v29, v43
    v_cvt_pk_bf16_f32 v58, v52, v53
    v_cvt_pk_bf16_f32 v59, v54, v55
    v_lshlrev_b32 v52, 16, v16
    v_lshlrev_b32 v53, 16, v20
    v_lshlrev_b32 v54, 16, v24
    v_lshlrev_b32 v55, 16, v28
    v_cvt_pk_bf16_f32 v60, v48, v49
    v_cvt_pk_bf16_f32 v61, v50, v51
    v_mfma_f32_16x16x32_bf16 v[104:107], v[68:71], v[56:59], v[104:107]
    v_mul_f32 v52, v52, v40
    v_mul_f32 v53, v53, v41
    v_mul_f32 v54, v54, v42
    v_mul_f32 v55, v55, v43
    v_mfma_f32_16x16x32_bf16 v[112:115], v[66:69], v[58:61], v[112:115]
    s_waitcnt vmcnt(4)
    v_lshlrev_b32 v48, 16, v32
    v_lshlrev_b32 v49, 16, v33
    v_lshlrev_b32 v50, 16, v34
    v_lshlrev_b32 v51, 16, v35
    v_mul_f32 v48, v48, v36
    v_mul_f32 v49, v49, v37
    v_mul_f32 v50, v50, v38
    v_mul_f32 v51, v51, v39
    v_mfma_f32_16x16x16_bf16 v[40:43], v[6:7], v[90:91], 0
    v_mfma_f32_16x16x16_bf16 v[44:47], v[6:7], v[94:95], 0
    v_mfma_f32_16x16x16_bf16 v[36:39], v[6:7], v[86:87], 0
    v_cvt_pk_bf16_f32 v56, v52, v53
    v_cvt_pk_bf16_f32 v57, v54, v55
    v_cvt_pk_bf16_f32 v60, v48, v49
    v_cvt_pk_bf16_f32 v61, v50, v51
    v_mfma_f32_16x16x32_bf16 v[120:123], v[72:75], v[56:59], v[120:123]
    v_lshlrev_b32 v52, 16, v19
    v_lshlrev_b32 v53, 16, v23
    v_lshlrev_b32 v54, 16, v27
    v_lshlrev_b32 v55, 16, v31
    v_mfma_f32_16x16x16_bf16 v[96:99], v[68:69], v[60:61], v[96:99]
    v_mul_f32 v48, v18, v40
    v_mul_f32 v49, v22, v41
    v_mul_f32 v50, v26, v42
    v_mul_f32 v51, v30, v43
    v_mul_f32 v52, v52, v44
    v_mul_f32 v53, v53, v45
    v_mul_f32 v54, v54, v46
    v_mul_f32 v55, v55, v47
    v_cvt_pk_bf16_f32 v56, v48, v49
    v_cvt_pk_bf16_f32 v57, v50, v51
    v_mul_f32 v48, v19, v40
    v_mul_f32 v49, v23, v41
    v_mul_f32 v50, v27, v42
    v_mul_f32 v51, v31, v43
    v_cvt_pk_bf16_f32 v58, v52, v53
    v_cvt_pk_bf16_f32 v59, v54, v55
    v_lshlrev_b32 v52, 16, v18
    v_lshlrev_b32 v53, 16, v22
    v_lshlrev_b32 v54, 16, v26
    v_lshlrev_b32 v55, 16, v30
    v_cvt_pk_bf16_f32 v60, v48, v49
    v_cvt_pk_bf16_f32 v61, v50, v51
    v_mfma_f32_16x16x32_bf16 v[108:111], v[68:71], v[56:59], v[108:111]
    v_mul_f32 v52, v52, v40
    v_mul_f32 v53, v53, v41
    v_mul_f32 v54, v54, v42
    v_mul_f32 v55, v55, v43
    v_mfma_f32_16x16x32_bf16 v[116:119], v[66:69], v[58:61], v[116:119]
    v_mul_f32 v48, v32, v36
    v_mul_f32 v49, v33, v37
    v_mul_f32 v50, v34, v38
    v_mul_f32 v51, v35, v39
    buffer_load_dword v32, v62, s[32:35], 0 idxen sc1
    buffer_load_dword v33, v63, s[32:35], 0 idxen sc1
    buffer_load_dword v34, v64, s[32:35], 0 idxen sc1
    buffer_load_dword v35, v65, s[32:35], 0 idxen sc1
    v_cvt_pk_bf16_f32 v56, v52, v53
    v_cvt_pk_bf16_f32 v57, v54, v55
    v_cvt_pk_bf16_f32 v60, v48, v49
    v_cvt_pk_bf16_f32 v61, v50, v51
    v_mfma_f32_16x16x32_bf16 v[124:127], v[72:75], v[56:59], v[124:127]
    v_add_u32 v3, 320, v3
    v_add_u32 v4, 320, v4
    v_mfma_f32_16x16x16_bf16 v[100:103], v[68:69], v[60:61], v[100:103]
    s_waitcnt lgkmcnt(0)
    v_add_u32 v5, v5, v2
    ds_read_b128 v[62:65], v3 offset:320
    ds_read_b64 v[6:7], v5
    ds_read_b128 v[66:69], v3 offset:16
    ds_read_b64 v[70:71], v3 offset:32
    ds_read_b64 v[74:75], v3 offset:40
    ds_read_u16 v5, v4 offset:368
    s_sub_u32 s71, s71, 1
    s_cmp_eq_u32 s71, 1
    s_cbranch_scc1 K2_B1L
K2_B1N:
    s_cmp_ge_u32 s71, 6
    s_cbranch_scc1 K2_p31N
    s_cmp_ge_u32 s71, 4
    s_cbranch_scc1 K2_p21N
    s_setprio 1
    s_branch K2_pd1N
K2_p31N:
    s_setprio 3
    s_branch K2_pd1N
K2_p21N:
    s_setprio 2
K2_pd1N:
    s_waitcnt lgkmcnt(1)
    v_mfma_f32_16x16x16_bf16 v[40:43], v[6:7], v[88:89], 0
    v_mfma_f32_16x16x16_bf16 v[44:47], v[6:7], v[92:93], 0
    v_mfma_f32_16x16x16_bf16 v[36:39], v[6:7], v[84:85], 0
    v_add_u32 v62, v62, v0
    v_add_u32 v63, v63, v0
    v_add_u32 v64, v64, v0
    v_add_u32 v65, v65, v0
    buffer_load_dwordx4 v[16:19], v62, s[28:31], 0 idxen sc1
    buffer_load_dwordx4 v[20:23], v63, s[28:31], 0 idxen sc1
    buffer_load_dwordx4 v[24:27], v64, s[28:31], 0 idxen sc1
    buffer_load_dwordx4 v[28:31], v65, s[28:31], 0 idxen sc1
    v_pk_lshlrev_b16 v50, v1, v68
    v_pk_lshlrev_b16 v51, v1, v69
    v_pk_ashrrev_i16 v50, 15, v50 op_sel_hi:[0,1]
    v_pk_ashrrev_i16 v51, 15, v51 op_sel_hi:[0,1]
    v_and_b32 v66, v50, v66
    v_and_b32 v70, v50, v70
    v_and_b32 v74, v50, v74
    v_and_b32 v68, 0x3f803f80, v50
    v_and_b32 v72, 0x3f803f80, v50
    v_and_b32 v67, v51, v67
    v_and_b32 v71, v51, v71
    v_and_b32 v75, v51, v75
    v_and_b32 v69, 0x3f803f80, v51
    v_and_b32 v73, 0x3f803f80, v51
    s_waitcnt vmcnt(8)
    v_lshlrev_b32 v52, 16, v9
    v_lshlrev_b32 v53, 16, v13
    v_lshlrev_b32 v54, 16, v77
    v_lshlrev_b32 v55, 16, v81
    v_mul_f32 v48, v8, v40
    v_mul_f32 v49, v12, v41
    v_mul_f32 v50, v76, v42
    v_mul_f32 v51, v80, v43
    v_mul_f32 v52, v52, v44
    v_mul_f32 v53, v53, v45
    v_mul_f32 v54, v54, v46
    v_mul_f32 v55, v55, v47
    v_cvt_pk_bf16_f32 v56, v48, v49
    v_cvt_pk_bf16_f32 v57, v50, v51
    v_mul_f32 v48, v9, v40
    v_mul_f32 v49, v13, v41
    v_mul_f32 v50, v77, v42
    v_mul_f32 v51, v81, v43
    v_cvt_pk_bf16_f32 v58, v52, v53
    v_cvt_pk_bf16_f32 v59, v54, v55
    v_lshlrev_b32 v52, 16, v8
    v_lshlrev_b32 v53, 16, v12
    v_lshlrev_b32 v54, 16, v76
    v_lshlrev_b32 v55, 16, v80
    v_cvt_pk_bf16_f32 v60, v48, v49
    v_cvt_pk_bf16_f32 v61, v50, v51
    v_mfma_f32_16x16x32_bf16 v[104:107], v[68:71], v[56:59], v[104:107]
    v_mul_f32 v52, v52, v40
    v_mul_f32 v53, v53, v41
    v_mul_f32 v54, v54, v42
    v_mul_f32 v55, v55, v43
    v_mfma_f32_16x16x32_bf16 v[112:115], v[66:69], v[58:61], v[112:115]
    s_waitcnt vmcnt(4)
    v_lshlrev_b32 v48, 16, v32
    v_lshlrev_b32 v49, 16, v33
    v_lshlrev_b32 v50, 16, v34
    v_lshlrev_b32 v51, 16, v35
    v_mul_f32 v48, v48, v36
    v_mul_f32 v49, v49, v37
    v_mul_f32 v50, v50, v38
    v_mul_f32 v51, v51, v39
    v_mfma_f32_16x16x16_bf16 v[40:43], v[6:7], v[90:91], 0
    v_mfma_f32_16x16x16_bf16 v[44:47], v[6:7], v[94:95], 0
    v_mfma_f32_16x16x16_bf16 v[36:39], v[6:7], v[86:87], 0
    v_cvt_pk_bf16_f32 v56, v52, v53
    v_cvt_pk_bf16_f32 v57, v54, v55
    v_cvt_pk_bf16_f32 v60, v48, v49
    v_cvt_pk_bf16_f32 v61, v50, v51
    v_mfma_f32_16x16x32_bf16 v[120:123], v[72:75], v[56:59], v[120:123]
    v_lshlrev_b32 v52, 16, v11
    v_lshlrev_b32 v53, 16, v15
    v_lshlrev_b32 v54, 16, v79
    v_lshlrev_b32 v55, 16, v83
    v_mfma_f32_16x16x16_bf16 v[96:99], v[68:69], v[60:61], v[96:99]
    v_mul_f32 v48, v10, v40
    v_mul_f32 v49, v14, v41
    v_mul_f32 v50, v78, v42
    v_mul_f32 v51, v82, v43
    v_mul_f32 v52, v52, v44
    v_mul_f32 v53, v53, v45
    v_mul_f32 v54, v54, v46
    v_mul_f32 v55, v55, v47
    v_cvt_pk_bf16_f32 v56, v48, v49
    v_cvt_pk_bf16_f32 v57, v50, v51
    v_mul_f32 v48, v11, v40
    v_mul_f32 v49, v15, v41
    v_mul_f32 v50, v79, v42
    v_mul_f32 v51, v83, v43
    v_cvt_pk_bf16_f32 v58, v52, v53
    v_cvt_pk_bf16_f32 v59, v54, v55
    v_lshlrev_b32 v52, 16, v10
    v_lshlrev_b32 v53, 16, v14
    v_lshlrev_b32 v54, 16, v78
    v_lshlrev_b32 v55, 16, v82
    v_cvt_pk_bf16_f32 v60, v48, v49
    v_cvt_pk_bf16_f32 v61, v50, v51
    v_mfma_f32_16x16x32_bf16 v[108:111], v[68:71], v[56:59], v[108:111]
    v_mul_f32 v52, v52, v40
    v_mul_f32 v53, v53, v41
    v_mul_f32 v54, v54, v42
    v_mul_f32 v55, v55, v43
    v_mfma_f32_16x16x32_bf16 v[116:119], v[66:69], v[58:61], v[116:119]
    v_mul_f32 v48, v32, v36
    v_mul_f32 v49, v33, v37
    v_mul_f32 v50, v34, v38
    v_mul_f32 v51, v35, v39
    buffer_load_dword v32, v62, s[32:35], 0 idxen sc1
    buffer_load_dword v33, v63, s[32:35], 0 idxen sc1
    buffer_load_dword v34, v64, s[32:35], 0 idxen sc1
    buffer_load_dword v35, v65, s[32:35], 0 idxen sc1
    v_cvt_pk_bf16_f32 v56, v52, v53
    v_cvt_pk_bf16_f32 v57, v54, v55
    v_cvt_pk_bf16_f32 v60, v48, v49
    v_cvt_pk_bf16_f32 v61, v50, v51
    v_mfma_f32_16x16x32_bf16 v[124:127], v[72:75], v[56:59], v[124:127]
    v_add_u32 v3, 320, v3
    v_add_u32 v4, 320, v4
    v_mfma_f32_16x16x16_bf16 v[100:103], v[68:69], v[60:61], v[100:103]
    s_waitcnt lgkmcnt(0)
    v_add_u32 v5, v5, v2
    ds_read_b128 v[62:65], v3 offset:320
    ds_read_b64 v[6:7], v5
    ds_read_b128 v[66:69], v3 offset:16
    ds_read_b64 v[70:71], v3 offset:32
    ds_read_b64 v[74:75], v3 offset:40
    ds_read_u16 v5, v4 offset:368
    s_sub_u32 s71, s71, 1
    s_cmp_eq_u32 s71, 1
    s_cbranch_scc1 K2_B0L
    s_branch K2_B0N
K2_B0L:
    s_setprio 0
    s_waitcnt lgkmcnt(1)
    v_mfma_f32_16x16x16_bf16 v[40:43], v[6:7], v[88:89], 0
    v_mfma_f32_16x16x16_bf16 v[44:47], v[6:7], v[92:93], 0
    v_mfma_f32_16x16x16_bf16 v[36:39], v[6:7], v[84:85], 0
    s_add_u32 s62, s65, s43
    s_cmp_lt_u32 s62, s64
    s_cbranch_scc1 K2_nores0L
    v_lshlrev_b32 v48, 9, v2
    v_lshl_add_u32 v49, v0, 2, s40
    v_add_u32 v48, v48, v49
    buffer_load_dword v8, v48, s[48:51], 0 offen offset:0
    buffer_load_dword v9, v48, s[48:51], 0 offen offset:1024
    buffer_load_dword v10, v48, s[48:51], 0 offen offset:2048
    buffer_load_dword v11, v48, s[48:51], 0 offen offset:3072
    buffer_load_dword v12, v48, s[48:51], 0 offen offset:256
    buffer_load_dword v13, v48, s[48:51], 0 offen offset:1280
    buffer_load_dword v14, v48, s[48:51], 0 offen offset:2304
    buffer_load_dword v15, v48, s[48:51], 0 offen offset:3328
    buffer_load_dword v76, v48, s[48:51], 0 offen offset:512
    buffer_load_dword v77, v48, s[48:51], 0 offen offset:1536
    buffer_load_dword v78, v48, s[48:51], 0 offen offset:2560
    buffer_load_dword v79, v48, s[48:51], 0 offen offset:3584
    buffer_load_dword v80, v48, s[48:51], 0 offen offset:768
    buffer_load_dword v81, v48, s[48:51], 0 offen offset:1792
    buffer_load_dword v82, v48, s[48:51], 0 offen offset:2816
    buffer_load_dword v83, v48, s[48:51], 0 offen offset:3840
    s_mov_b32 s41, 2
K2_nores0L:
    v_pk_lshlrev_b16 v50, v1, v68
    v_pk_lshlrev_b16 v51, v1, v69
    v_pk_ashrrev_i16 v50, 15, v50 op_sel_hi:[0,1]
    v_pk_ashrrev_i16 v51, 15, v51 op_sel_hi:[0,1]
    v_and_b32 v66, v50, v66
    v_and_b32 v70, v50, v70
    v_and_b32 v74, v50, v74
    v_and_b32 v68, 0x3f803f80, v50
    v_and_b32 v72, 0x3f803f80, v50
    v_and_b32 v67, v51, v67
    v_and_b32 v71, v51, v71
    v_and_b32 v75, v51, v75
    v_and_b32 v69, 0x3f803f80, v51
    v_and_b32 v73, 0x3f803f80, v51
    s_add_u32 s62, s65, s43
    s_cmp_lt_u32 s62, s64
    s_cbranch_scc1 K2_w0a0L
    s_waitcnt vmcnt(20)
    s_branch K2_w0b0L
K2_w0a0L:
    s_waitcnt vmcnt(4)
K2_w0b0L:
    v_lshlrev_b32 v52, 16, v17
    v_lshlrev_b32 v53, 16, v21
    v_lshlrev_b32 v54, 16, v25
    v_lshlrev_b32 v55, 16, v29
    v_mul_f32 v48, v16, v40
    v_mul_f32 v49, v20, v41
    v_mul_f32 v50, v24, v42
    v_mul_f32 v51, v28, v43
    v_mul_f32 v52, v52, v44
    v_mul_f32 v53, v53, v45
    v_mul_f32 v54, v54, v46
    v_mul_f32 v55, v55, v47
    v_cvt_pk_bf16_f32 v56, v48, v49
    v_cvt_pk_bf16_f32 v57, v50, v51
    v_mul_f32 v48, v17, v40
    v_mul_f32 v49, v21, v41
    v_mul_f32 v50, v25, v42
    v_mul_f32 v51, v29, v43
    v_cvt_pk_bf16_f32 v58, v52, v53
    v_cvt_pk_bf16_f32 v59, v54, v55
    v_lshlrev_b32 v52, 16, v16
    v_lshlrev_b32 v53, 16, v20
    v_lshlrev_b32 v54, 16, v24
    v_lshlrev_b32 v55, 16, v28
    v_cvt_pk_bf16_f32 v60, v48, v49
    v_cvt_pk_bf16_f32 v61, v50, v51
    v_mfma_f32_16x16x32_bf16 v[104:107], v[68:71], v[56:59], v[104:107]
    v_mul_f32 v52, v52, v40
    v_mul_f32 v53, v53, v41
    v_mul_f32 v54, v54, v42
    v_mul_f32 v55, v55, v43
    v_mfma_f32_16x16x32_bf16 v[112:115], v[66:69], v[58:61], v[112:115]
    s_add_u32 s62, s65, s43
    s_cmp_lt_u32 s62, s64
    s_cbranch_scc1 K2_w1a0L
    s_waitcnt vmcnt(16)
    s_branch K2_w1b0L
K2_w1a0L:
    s_waitcnt vmcnt(0)
K2_w1b0L:
    v_lshlrev_b32 v48, 16, v32
    v_lshlrev_b32 v49, 16, v33
    v_lshlrev_b32 v50, 16, v34
    v_lshlrev_b32 v51, 16, v35
    v_mul_f32 v48, v48, v36
    v_mul_f32 v49, v49, v37
    v_mul_f32 v50, v50, v38
    v_mul_f32 v51, v51, v39
    v_mfma_f32_16x16x16_bf16 v[40:43], v[6:7], v[90:91], 0
    v_mfma_f32_16x16x16_bf16 v[44:47], v[6:7], v[94:95], 0
    v_mfma_f32_16x16x16_bf16 v[36:39], v[6:7], v[86:87], 0
    v_cvt_pk_bf16_f32 v56, v52, v53
    v_cvt_pk_bf16_f32 v57, v54, v55
    v_cvt_pk_bf16_f32 v60, v48, v49
    v_cvt_pk_bf16_f32 v61, v50, v51
    v_mfma_f32_16x16x32_bf16 v[120:123], v[72:75], v[56:59], v[120:123]
    v_lshlrev_b32 v52, 16, v19
    v_lshlrev_b32 v53, 16, v23
    v_lshlrev_b32 v54, 16, v27
    v_lshlrev_b32 v55, 16, v31
    v_mfma_f32_16x16x16_bf16 v[96:99], v[68:69], v[60:61], v[96:99]
    v_mul_f32 v48, v18, v40
    v_mul_f32 v49, v22, v41
    v_mul_f32 v50, v26, v42
    v_mul_f32 v51, v30, v43
    v_mul_f32 v52, v52, v44
    v_mul_f32 v53, v53, v45
    v_mul_f32 v54, v54, v46
    v_mul_f32 v55, v55, v47
    v_cvt_pk_bf16_f32 v56, v48, v49
    v_cvt_pk_bf16_f32 v57, v50, v51
    v_mul_f32 v48, v19, v40
    v_mul_f32 v49, v23, v41
    v_mul_f32 v50, v27, v42
    v_mul_f32 v51, v31, v43
    v_cvt_pk_bf16_f32 v58, v52, v53
    v_cvt_pk_bf16_f32 v59, v54, v55
    v_lshlrev_b32 v52, 16, v18
    v_lshlrev_b32 v53, 16, v22
    v_lshlrev_b32 v54, 16, v26
    v_lshlrev_b32 v55, 16, v30
    v_cvt_pk_bf16_f32 v60, v48, v49
    v_cvt_pk_bf16_f32 v61, v50, v51
    v_mfma_f32_16x16x32_bf16 v[108:111], v[68:71], v[56:59], v[108:111]
    v_mul_f32 v52, v52, v40
    v_mul_f32 v53, v53, v41
    v_mul_f32 v54, v54, v42
    v_mul_f32 v55, v55, v43
    v_mfma_f32_16x16x32_bf16 v[116:119], v[66:69], v[58:61], v[116:119]
    v_mul_f32 v48, v32, v36
    v_mul_f32 v49, v33, v37
    v_mul_f32 v50, v34, v38
    v_mul_f32 v51, v35, v39
    v_cvt_pk_bf16_f32 v56, v52, v53
    v_cvt_pk_bf16_f32 v57, v54, v55
    v_cvt_pk_bf16_f32 v60, v48, v49
    v_cvt_pk_bf16_f32 v61, v50, v51
    v_mfma_f32_16x16x32_bf16 v[124:127], v[72:75], v[56:59], v[124:127]
s_nop 0
    v_mfma_f32_16x16x16_bf16 v[100:103], v[68:69], v[60:61], v[100:103]
    s_waitcnt lgkmcnt(0)
    s_branch K2_chunk_end
K2_B1L:
    s_setprio 0
    s_waitcnt lgkmcnt(1)
    v_mfma_f32_16x16x16_bf16 v[40:43], v[6:7], v[88:89], 0
    v_mfma_f32_16x16x16_bf16 v[44:47], v[6:7], v[92:93], 0
    v_mfma_f32_16x16x16_bf16 v[36:39], v[6:7], v[84:85], 0
    s_add_u32 s62, s65, s43
    s_cmp_lt_u32 s62, s64
    s_cbranch_scc1 K2_nores1L
    v_lshlrev_b32 v48, 9, v2
    v_lshl_add_u32 v49, v0, 2, s40
    v_add_u32 v48, v48, v49
    buffer_load_dword v16, v48, s[48:51], 0 offen offset:0
    buffer_load_dword v17, v48, s[48:51], 0 offen offset:1024
    buffer_load_dword v18, v48, s[48:51], 0 offen offset:2048
    buffer_load_dword v19, v48, s[48:51], 0 offen offset:3072
    buffer_load_dword v20, v48, s[48:51], 0 offen offset:256
    buffer_load_dword v21, v48, s[48:51], 0 offen offset:1280
    buffer_load_dword v22, v48, s[48:51], 0 offen offset:2304
    buffer_load_dword v23, v48, s[48:51], 0 offen offset:3328
    buffer_load_dword v24, v48, s[48:51], 0 offen offset:512
    buffer_load_dword v25, v48, s[48:51], 0 offen offset:1536
    buffer_load_dword v26, v48, s[48:51], 0 offen offset:2560
    buffer_load_dword v27, v48, s[48:51], 0 offen offset:3584
    buffer_load_dword v28, v48, s[48:51], 0 offen offset:768
    buffer_load_dword v29, v48, s[48:51], 0 offen offset:1792
    buffer_load_dword v30, v48, s[48:51], 0 offen offset:2816
    buffer_load_dword v31, v48, s[48:51], 0 offen offset:3840
    s_mov_b32 s41, 1
K2_nores1L:
    v_pk_lshlrev_b16 v50, v1, v68
    v_pk_lshlrev_b16 v51, v1, v69
    v_pk_ashrrev_i16 v50, 15, v50 op_sel_hi:[0,1]
    v_pk_ashrrev_i16 v51, 15, v51 op_sel_hi:[0,1]
    v_and_b32 v66, v50, v66
    v_and_b32 v70, v50, v70
    v_and_b32 v74, v50, v74
    v_and_b32 v68, 0x3f803f80, v50
    v_and_b32 v72, 0x3f803f80, v50
    v_and_b32 v67, v51, v67
    v_and_b32 v71, v51, v71
    v_and_b32 v75, v51, v75
    v_and_b32 v69, 0x3f803f80, v51
    v_and_b32 v73, 0x3f803f80, v51
    s_add_u32 s62, s65, s43
    s_cmp_lt_u32 s62, s64
    s_cbranch_scc1 K2_w0a1L
    s_waitcnt vmcnt(20)
    s_branch K2_w0b1L
K2_w0a1L:
    s_waitcnt vmcnt(4)
K2_w0b1L:
    v_lshlrev_b32 v52, 16, v9
    v_lshlrev_b32 v53, 16, v13
    v_lshlrev_b32 v54, 16, v77
    v_lshlrev_b32 v55, 16, v81
    v_mul_f32 v48, v8, v40
    v_mul_f32 v49, v12, v41
    v_mul_f32 v50, v76, v42
    v_mul_f32 v51, v80, v43
    v_mul_f32 v52, v52, v44
    v_mul_f32 v53, v53, v45
    v_mul_f32 v54, v54, v46
    v_mul_f32 v55, v55, v47
    v_cvt_pk_bf16_f32 v56, v48, v49
    v_cvt_pk_bf16_f32 v57, v50, v51
    v_mul_f32 v48, v9, v40
    v_mul_f32 v49, v13, v41
    v_mul_f32 v50, v77, v42
    v_mul_f32 v51, v81, v43
    v_cvt_pk_bf16_f32 v58, v52, v53
    v_cvt_pk_bf16_f32 v59, v54, v55
    v_lshlrev_b32 v52, 16, v8
    v_lshlrev_b32 v53, 16, v12
    v_lshlrev_b32 v54, 16, v76
    v_lshlrev_b32 v55, 16, v80
    v_cvt_pk_bf16_f32 v60, v48, v49
    v_cvt_pk_bf16_f32 v61, v50, v51
    v_mfma_f32_16x16x32_bf16 v[104:107], v[68:71], v[56:59], v[104:107]
    v_mul_f32 v52, v52, v40
    v_mul_f32 v53, v53, v41
    v_mul_f32 v54, v54, v42
    v_mul_f32 v55, v55, v43
    v_mfma_f32_16x16x32_bf16 v[112:115], v[66:69], v[58:61], v[112:115]
    s_add_u32 s62, s65, s43
    s_cmp_lt_u32 s62, s64
    s_cbranch_scc1 K2_w1a1L
    s_waitcnt vmcnt(16)
    s_branch K2_w1b1L
K2_w1a1L:
    s_waitcnt vmcnt(0)
K2_w1b1L:
    v_lshlrev_b32 v48, 16, v32
    v_lshlrev_b32 v49, 16, v33
    v_lshlrev_b32 v50, 16, v34
    v_lshlrev_b32 v51, 16, v35
    v_mul_f32 v48, v48, v36
    v_mul_f32 v49, v49, v37
    v_mul_f32 v50, v50, v38
    v_mul_f32 v51, v51, v39
    v_mfma_f32_16x16x16_bf16 v[40:43], v[6:7], v[90:91], 0
    v_mfma_f32_16x16x16_bf16 v[44:47], v[6:7], v[94:95], 0
    v_mfma_f32_16x16x16_bf16 v[36:39], v[6:7], v[86:87], 0
    v_cvt_pk_bf16_f32 v56, v52, v53
    v_cvt_pk_bf16_f32 v57, v54, v55
    v_cvt_pk_bf16_f32 v60, v48, v49
    v_cvt_pk_bf16_f32 v61, v50, v51
    v_mfma_f32_16x16x32_bf16 v[120:123], v[72:75], v[56:59], v[120:123]
    v_lshlrev_b32 v52, 16, v11
    v_lshlrev_b32 v53, 16, v15
    v_lshlrev_b32 v54, 16, v79
    v_lshlrev_b32 v55, 16, v83
    v_mfma_f32_16x16x16_bf16 v[96:99], v[68:69], v[60:61], v[96:99]
    v_mul_f32 v48, v10, v40
    v_mul_f32 v49, v14, v41
    v_mul_f32 v50, v78, v42
    v_mul_f32 v51, v82, v43
    v_mul_f32 v52, v52, v44
    v_mul_f32 v53, v53, v45
    v_mul_f32 v54, v54, v46
    v_mul_f32 v55, v55, v47
    v_cvt_pk_bf16_f32 v56, v48, v49
    v_cvt_pk_bf16_f32 v57, v50, v51
    v_mul_f32 v48, v11, v40
    v_mul_f32 v49, v15, v41
    v_mul_f32 v50, v79, v42
    v_mul_f32 v51, v83, v43
    v_cvt_pk_bf16_f32 v58, v52, v53
    v_cvt_pk_bf16_f32 v59, v54, v55
    v_lshlrev_b32 v52, 16, v10
    v_lshlrev_b32 v53, 16, v14
    v_lshlrev_b32 v54, 16, v78
    v_lshlrev_b32 v55, 16, v82
    v_cvt_pk_bf16_f32 v60, v48, v49
    v_cvt_pk_bf16_f32 v61, v50, v51
    v_mfma_f32_16x16x32_bf16 v[108:111], v[68:71], v[56:59], v[108:111]
    v_mul_f32 v52, v52, v40
    v_mul_f32 v53, v53, v41
    v_mul_f32 v54, v54, v42
    v_mul_f32 v55, v55, v43
    v_mfma_f32_16x16x32_bf16 v[116:119], v[66:69], v[58:61], v[116:119]
    v_mul_f32 v48, v32, v36
    v_mul_f32 v49, v33, v37
    v_mul_f32 v50, v34, v38
    v_mul_f32 v51, v35, v39
    v_cvt_pk_bf16_f32 v56, v52, v53
    v_cvt_pk_bf16_f32 v57, v54, v55
    v_cvt_pk_bf16_f32 v60, v48, v49
    v_cvt_pk_bf16_f32 v61, v50, v51
    v_mfma_f32_16x16x32_bf16 v[124:127], v[72:75], v[56:59], v[124:127]
s_nop 0
    v_mfma_f32_16x16x16_bf16 v[100:103], v[68:69], v[60:61], v[100:103]
    s_waitcnt lgkmcnt(0)
    s_branch K2_chunk_end
K2_chunk_end:
    s_cmp_lg_u32 s67, 0
    s_cbranch_scc1 K2_init_e
    s_mov_b32 s67, 1
    v_mul_u32_u24 v48, 96, v2
    v_lshl_add_u32 v48, v0, 2, v48
    v_add_u32 v48, 147456, v48
    ds_read_b32 v36, v48 offset:0
    ds_read_b32 v37, v48 offset:192
    ds_read_b32 v38, v48 offset:384
    ds_read_b32 v39, v48 offset:576
    ds_read_b32 v40, v48 offset:64
    ds_read_b32 v41, v48 offset:256
    ds_read_b32 v42, v48 offset:448
    ds_read_b32 v43, v48 offset:640
    ds_read_b32 v44, v48 offset:128
    ds_read_b32 v45, v48 offset:320
    ds_read_b32 v46, v48 offset:512
    ds_read_b32 v47, v48 offset:704
    v_mov_b32 v96, 0
    v_mov_b32 v97, 0
    v_mov_b32 v98, 0
    v_mov_b32 v99, 0
    v_mov_b32 v100, 0
    v_mov_b32 v101, 0
    v_mov_b32 v102, 0
    v_mov_b32 v103, 0
    v_mov_b32 v104, 0
    v_mov_b32 v105, 0
    v_mov_b32 v106, 0
    v_mov_b32 v107, 0
    v_mov_b32 v108, 0
    v_mov_b32 v109, 0
    v_mov_b32 v110, 0
    v_mov_b32 v111, 0
    v_mov_b32 v112, 0
    v_mov_b32 v113, 0
    v_mov_b32 v114, 0
    v_mov_b32 v115, 0
    v_mov_b32 v116, 0
    v_mov_b32 v117, 0
    v_mov_b32 v118, 0
    v_mov_b32 v119, 0
    v_mov_b32 v120, 0
    v_mov_b32 v121, 0
    v_mov_b32 v122, 0
    v_mov_b32 v123, 0
    v_mov_b32 v124, 0
    v_mov_b32 v125, 0
    v_mov_b32 v126, 0
    v_mov_b32 v127, 0
    s_mov_b32 s62, 0x05040100
    s_mov_b32 s63, 0x07060302
    s_waitcnt lgkmcnt(0)
    v_perm_b32 v84, v37, v36, s62
    v_perm_b32 v85, v39, v38, s62
    v_perm_b32 v86, v37, v36, s63
    v_perm_b32 v87, v39, v38, s63
    v_perm_b32 v88, v41, v40, s62
    v_perm_b32 v89, v43, v42, s62
    v_perm_b32 v90, v41, v40, s63
    v_perm_b32 v91, v43, v42, s63
    v_perm_b32 v92, v45, v44, s62
    v_perm_b32 v93, v47, v46, s62
    v_perm_b32 v94, v45, v44, s63
    v_perm_b32 v95, v47, v46, s63
K2_init_e:
    s_add_u32 s65, s65, s43
    s_cmp_lt_u32 s65, s64
    s_cbranch_scc0 K2_epi
    s_mov_b32 s41, 0
    s_waitcnt vmcnt(0)
    s_barrier
    s_branch K2_chunk
K2_epi:
    s_setprio 0
    v_lshlrev_b32 v36, 9, v2
    v_lshl_add_u32 v37, v0, 2, s40
    v_add_u32 v36, v36, v37
    s_cmp_eq_u32 s41, 2
    s_cbranch_scc1 K2_epi1
    s_cmp_eq_u32 s41, 1
    s_cbranch_scc1 K2_epi0
    buffer_load_dword v16, v36, s[48:51], 0 offen offset:0
    buffer_load_dword v17, v36, s[48:51], 0 offen offset:1024
    buffer_load_dword v18, v36, s[48:51], 0 offen offset:2048
    buffer_load_dword v19, v36, s[48:51], 0 offen offset:3072
    buffer_load_dword v20, v36, s[48:51], 0 offen offset:256
    buffer_load_dword v21, v36, s[48:51], 0 offen offset:1280
    buffer_load_dword v22, v36, s[48:51], 0 offen offset:2304
    buffer_load_dword v23, v36, s[48:51], 0 offen offset:3328
    buffer_load_dword v24, v36, s[48:51], 0 offen offset:512
    buffer_load_dword v25, v36, s[48:51], 0 offen offset:1536
    buffer_load_dword v26, v36, s[48:51], 0 offen offset:2560
    buffer_load_dword v27, v36, s[48:51], 0 offen offset:3584
    buffer_load_dword v28, v36, s[48:51], 0 offen offset:768
    buffer_load_dword v29, v36, s[48:51], 0 offen offset:1792
    buffer_load_dword v30, v36, s[48:51], 0 offen offset:2816
    buffer_load_dword v31, v36, s[48:51], 0 offen offset:3840
K2_epi0:
    s_waitcnt vmcnt(12)
    v_and_b32 v40, 0xffff0000, v16
    v_lshlrev_b32 v44, 16, v16
    v_and_b32 v41, 0xffff0000, v17
    v_lshlrev_b32 v45, 16, v17
    v_and_b32 v42, 0xffff0000, v18
    v_lshlrev_b32 v46, 16, v18
    v_and_b32 v43, 0xffff0000, v19
    v_lshlrev_b32 v47, 16, v19
    v_add_f32 v100, v100, v40
    v_add_f32 v96, v96, v44
    v_add_f32 v101, v101, v41
    v_add_f32 v97, v97, v45
    v_add_f32 v102, v102, v42
    v_add_f32 v98, v98, v46
    v_add_f32 v103, v103, v43
    v_add_f32 v99, v99, v47
    v_cvt_pk_bf16_f32 v48, v96, v100
    v_cvt_pk_bf16_f32 v49, v97, v101
    v_cvt_pk_bf16_f32 v50, v98, v102
    v_cvt_pk_bf16_f32 v51, v99, v103
    buffer_store_dword v48, v36, s[52:55], 0 offen offset:0 sc0 sc1 nt
    buffer_store_dword v49, v36, s[52:55], 0 offen offset:1024 sc0 sc1 nt
    buffer_store_dword v50, v36, s[52:55], 0 offen offset:2048 sc0 sc1 nt
    buffer_store_dword v51, v36, s[52:55], 0 offen offset:3072 sc0 sc1 nt
    s_waitcnt vmcnt(12)
    v_and_b32 v40, 0xffff0000, v20
    v_lshlrev_b32 v44, 16, v20
    v_and_b32 v41, 0xffff0000, v21
    v_lshlrev_b32 v45, 16, v21
    v_and_b32 v42, 0xffff0000, v22
    v_lshlrev_b32 v46, 16, v22
    v_and_b32 v43, 0xffff0000, v23
    v_lshlrev_b32 v47, 16, v23
    v_add_f32 v108, v108, v40
    v_add_f32 v104, v104, v44
    v_add_f32 v109, v109, v41
    v_add_f32 v105, v105, v45
    v_add_f32 v110, v110, v42
    v_add_f32 v106, v106, v46
    v_add_f32 v111, v111, v43
    v_add_f32 v107, v107, v47
    v_cvt_pk_bf16_f32 v52, v104, v108
    v_cvt_pk_bf16_f32 v53, v105, v109
    v_cvt_pk_bf16_f32 v54, v106, v110
    v_cvt_pk_bf16_f32 v55, v107, v111
    buffer_store_dword v52, v36, s[52:55], 0 offen offset:256 sc0 sc1 nt
    buffer_store_dword v53, v36, s[52:55], 0 offen offset:1280 sc0 sc1 nt
    buffer_store_dword v54, v36, s[52:55], 0 offen offset:2304 sc0 sc1 nt
    buffer_store_dword v55, v36, s[52:55], 0 offen offset:3328 sc0 sc1 nt
    s_waitcnt vmcnt(12)
    v_and_b32 v40, 0xffff0000, v24
    v_lshlrev_b32 v44, 16, v24
    v_and_b32 v41, 0xffff0000, v25
    v_lshlrev_b32 v45, 16, v25
    v_and_b32 v42, 0xffff0000, v26
    v_lshlrev_b32 v46, 16, v26
    v_and_b32 v43, 0xffff0000, v27
    v_lshlrev_b32 v47, 16, v27
    v_add_f32 v116, v116, v40
    v_add_f32 v112, v112, v44
    v_add_f32 v117, v117, v41
    v_add_f32 v113, v113, v45
    v_add_f32 v118, v118, v42
    v_add_f32 v114, v114, v46
    v_add_f32 v119, v119, v43
    v_add_f32 v115, v115, v47
    v_cvt_pk_bf16_f32 v56, v112, v116
    v_cvt_pk_bf16_f32 v57, v113, v117
    v_cvt_pk_bf16_f32 v58, v114, v118
    v_cvt_pk_bf16_f32 v59, v115, v119
    buffer_store_dword v56, v36, s[52:55], 0 offen offset:512 sc0 sc1 nt
    buffer_store_dword v57, v36, s[52:55], 0 offen offset:1536 sc0 sc1 nt
    buffer_store_dword v58, v36, s[52:55], 0 offen offset:2560 sc0 sc1 nt
    buffer_store_dword v59, v36, s[52:55], 0 offen offset:3584 sc0 sc1 nt
    s_waitcnt vmcnt(12)
    v_and_b32 v40, 0xffff0000, v28
    v_lshlrev_b32 v44, 16, v28
    v_and_b32 v41, 0xffff0000, v29
    v_lshlrev_b32 v45, 16, v29
    v_and_b32 v42, 0xffff0000, v30
    v_lshlrev_b32 v46, 16, v30
    v_and_b32 v43, 0xffff0000, v31
    v_lshlrev_b32 v47, 16, v31
    v_add_f32 v124, v124, v40
    v_add_f32 v120, v120, v44
    v_add_f32 v125, v125, v41
    v_add_f32 v121, v121, v45
    v_add_f32 v126, v126, v42
    v_add_f32 v122, v122, v46
    v_add_f32 v127, v127, v43
    v_add_f32 v123, v123, v47
    v_cvt_pk_bf16_f32 v60, v120, v124
    v_cvt_pk_bf16_f32 v61, v121, v125
    v_cvt_pk_bf16_f32 v62, v122, v126
    v_cvt_pk_bf16_f32 v63, v123, v127
    buffer_store_dword v60, v36, s[52:55], 0 offen offset:768 sc0 sc1 nt
    buffer_store_dword v61, v36, s[52:55], 0 offen offset:1792 sc0 sc1 nt
    buffer_store_dword v62, v36, s[52:55], 0 offen offset:2816 sc0 sc1 nt
    buffer_store_dword v63, v36, s[52:55], 0 offen offset:3840 sc0 sc1 nt
    s_branch K2_fin
K2_epi1:
    s_waitcnt vmcnt(12)
    v_and_b32 v40, 0xffff0000, v8
    v_lshlrev_b32 v44, 16, v8
    v_and_b32 v41, 0xffff0000, v9
    v_lshlrev_b32 v45, 16, v9
    v_and_b32 v42, 0xffff0000, v10
    v_lshlrev_b32 v46, 16, v10
    v_and_b32 v43, 0xffff0000, v11
    v_lshlrev_b32 v47, 16, v11
    v_add_f32 v100, v100, v40
    v_add_f32 v96, v96, v44
    v_add_f32 v101, v101, v41
    v_add_f32 v97, v97, v45
    v_add_f32 v102, v102, v42
    v_add_f32 v98, v98, v46
    v_add_f32 v103, v103, v43
    v_add_f32 v99, v99, v47
    v_cvt_pk_bf16_f32 v48, v96, v100
    v_cvt_pk_bf16_f32 v49, v97, v101
    v_cvt_pk_bf16_f32 v50, v98, v102
    v_cvt_pk_bf16_f32 v51, v99, v103
    buffer_store_dword v48, v36, s[52:55], 0 offen offset:0 sc0 sc1 nt
    buffer_store_dword v49, v36, s[52:55], 0 offen offset:1024 sc0 sc1 nt
    buffer_store_dword v50, v36, s[52:55], 0 offen offset:2048 sc0 sc1 nt
    buffer_store_dword v51, v36, s[52:55], 0 offen offset:3072 sc0 sc1 nt
    s_waitcnt vmcnt(12)
    v_and_b32 v40, 0xffff0000, v12
    v_lshlrev_b32 v44, 16, v12
    v_and_b32 v41, 0xffff0000, v13
    v_lshlrev_b32 v45, 16, v13
    v_and_b32 v42, 0xffff0000, v14
    v_lshlrev_b32 v46, 16, v14
    v_and_b32 v43, 0xffff0000, v15
    v_lshlrev_b32 v47, 16, v15
    v_add_f32 v108, v108, v40
    v_add_f32 v104, v104, v44
    v_add_f32 v109, v109, v41
    v_add_f32 v105, v105, v45
    v_add_f32 v110, v110, v42
    v_add_f32 v106, v106, v46
    v_add_f32 v111, v111, v43
    v_add_f32 v107, v107, v47
    v_cvt_pk_bf16_f32 v52, v104, v108
    v_cvt_pk_bf16_f32 v53, v105, v109
    v_cvt_pk_bf16_f32 v54, v106, v110
    v_cvt_pk_bf16_f32 v55, v107, v111
    buffer_store_dword v52, v36, s[52:55], 0 offen offset:256 sc0 sc1 nt
    buffer_store_dword v53, v36, s[52:55], 0 offen offset:1280 sc0 sc1 nt
    buffer_store_dword v54, v36, s[52:55], 0 offen offset:2304 sc0 sc1 nt
    buffer_store_dword v55, v36, s[52:55], 0 offen offset:3328 sc0 sc1 nt
    s_waitcnt vmcnt(12)
    v_and_b32 v40, 0xffff0000, v76
    v_lshlrev_b32 v44, 16, v76
    v_and_b32 v41, 0xffff0000, v77
    v_lshlrev_b32 v45, 16, v77
    v_and_b32 v42, 0xffff0000, v78
    v_lshlrev_b32 v46, 16, v78
    v_and_b32 v43, 0xffff0000, v79
    v_lshlrev_b32 v47, 16, v79
    v_add_f32 v116, v116, v40
    v_add_f32 v112, v112, v44
    v_add_f32 v117, v117, v41
    v_add_f32 v113, v113, v45
    v_add_f32 v118, v118, v42
    v_add_f32 v114, v114, v46
    v_add_f32 v119, v119, v43
    v_add_f32 v115, v115, v47
    v_cvt_pk_bf16_f32 v56, v112, v116
    v_cvt_pk_bf16_f32 v57, v113, v117
    v_cvt_pk_bf16_f32 v58, v114, v118
    v_cvt_pk_bf16_f32 v59, v115, v119
    buffer_store_dword v56, v36, s[52:55], 0 offen offset:512 sc0 sc1 nt
    buffer_store_dword v57, v36, s[52:55], 0 offen offset:1536 sc0 sc1 nt
    buffer_store_dword v58, v36, s[52:55], 0 offen offset:2560 sc0 sc1 nt
    buffer_store_dword v59, v36, s[52:55], 0 offen offset:3584 sc0 sc1 nt
    s_waitcnt vmcnt(12)
    v_and_b32 v40, 0xffff0000, v80
    v_lshlrev_b32 v44, 16, v80
    v_and_b32 v41, 0xffff0000, v81
    v_lshlrev_b32 v45, 16, v81
    v_and_b32 v42, 0xffff0000, v82
    v_lshlrev_b32 v46, 16, v82
    v_and_b32 v43, 0xffff0000, v83
    v_lshlrev_b32 v47, 16, v83
    v_add_f32 v124, v124, v40
    v_add_f32 v120, v120, v44
    v_add_f32 v125, v125, v41
    v_add_f32 v121, v121, v45
    v_add_f32 v126, v126, v42
    v_add_f32 v122, v122, v46
    v_add_f32 v127, v127, v43
    v_add_f32 v123, v123, v47
    v_cvt_pk_bf16_f32 v60, v120, v124
    v_cvt_pk_bf16_f32 v61, v121, v125
    v_cvt_pk_bf16_f32 v62, v122, v126
    v_cvt_pk_bf16_f32 v63, v123, v127
    buffer_store_dword v60, v36, s[52:55], 0 offen offset:768 sc0 sc1 nt
    buffer_store_dword v61, v36, s[52:55], 0 offen offset:1792 sc0 sc1 nt
    buffer_store_dword v62, v36, s[52:55], 0 offen offset:2816 sc0 sc1 nt
    buffer_store_dword v63, v36, s[52:55], 0 offen offset:3840 sc0 sc1 nt
K2_fin:
K_exit:
    s_endpgm
.section .rodata,"a"
.p2align 6
.amdhsa_kernel gather_scatter__molecular_angular_painn__graph_kernel
  .amdhsa_next_free_vgpr 128
  .amdhsa_next_free_sgpr 102
  .amdhsa_accum_offset 128
  .amdhsa_group_segment_fixed_size 0
  .amdhsa_kernarg_size 88
  .amdhsa_user_sgpr_count 2
  .amdhsa_user_sgpr_kernarg_segment_ptr 1
  .amdhsa_system_sgpr_workgroup_id_x 1
.end_amdhsa_kernel
```
